```python
import torch

def _softmax(x, axis=-1):
    return torch.softmax(x, dim=axis)
def _gelu(x):
    return torch.nn.functional.gelu(x, approximate="tanh")
def _silu(x):
    return torch.nn.functional.silu(x)
def _sigmoid(x):
    return torch.sigmoid(x)
def _layernorm(x, axis=-1, eps=1e-5):
    m = x.mean(dim=axis, keepdim=True)
    v = x.var(dim=axis, keepdim=True, unbiased=False)
    return (x - m) / torch.sqrt(v + eps)
def _scatter_add(tgt, idx, src, axis=0):
    return tgt.clone().index_add_(axis, idx, src)
def _segment_sum(src, seg, n):
    out = torch.zeros((n,) + src.shape[1:], dtype=src.dtype)
    return out.index_add_(0, seg, src)
def _pad(x, pw):
    flat = tuple(v for pair in reversed(pw) for v in pair)
    return torch.nn.functional.pad(x, flat)

kernel_name = 'interleave_layers__linear_attn_block__glu_gated_swiglu__prompt'

def setup_inputs():

    _w = (lambda a: (lambda t: t.to(torch.bfloat16) if t.is_floating_point() else t)(torch.as_tensor(a)))
    def _A_setup():
        B, S, D = 1, 2048, 512
        return {
            "x": _w((lambda *s: torch.randn(*s, dtype=torch.bfloat16) * 0.05)(B, S, D)),
            "wqkv": _w((lambda *s: torch.randn(*s, dtype=torch.bfloat16) * 0.05)(D, 3 * D)),
            "wo": _w((lambda *s: torch.randn(*s, dtype=torch.bfloat16) * 0.05)(D, D)),
        }
    _A_in = _A_setup()

    def _B_setup():
        B, S, D, F = 1, 2048, 512, 1792
        return {
            "x": _w((lambda *s: torch.randn(*s, dtype=torch.bfloat16) * 0.05)(B, S, D)),
            "w1": _w((lambda *s: torch.randn(*s, dtype=torch.bfloat16) * 0.4)(D, F) * (2.0 / D) ** 0.5),
            "w3": _w((lambda *s: torch.randn(*s, dtype=torch.bfloat16) * 0.4)(D, F) * (2.0 / D) ** 0.5),
            "w2": _w((lambda *s: torch.randn(*s, dtype=torch.bfloat16) * 0.4)(F, D) * (2.0 / F) ** 0.5),
        }
    _B_in = _B_setup()

    return {
        "A_x": _A_in["x"],
        "A_wqkv": _A_in["wqkv"],
        "A_wo": _A_in["wo"],
        "B_x": _B_in["x"],
        "B_w1": _B_in["w1"],
        "B_w3": _B_in["w3"],
        "B_w2": _B_in["w2"],
    }

def reference(A_x, A_wqkv, A_wo, B_x, B_w1, B_w3, B_w2):
    def _A_ref(x, wqkv, wo):
        B, S, D = x.shape
        H = 32; Dh = D // H
        qkv = (lambda x, *d: x.permute(*d))((x @ wqkv).reshape(B, S, 3, H, Dh), 2, 0, 3, 1, 4)
        q, k, v = qkv[0], qkv[1], qkv[2]
        phi = lambda t: torch.where(t > 0, t + 1, torch.exp(t)) + 1e-6
        pq, pk = phi(q), phi(k)
        kv = torch.einsum("bhsd,bhse->bhde", pk, v)
        z = torch.einsum("bhsd->bhd", pk)
        num = torch.einsum("bhqd,bhde->bhqe", pq, kv)
        den = torch.einsum("bhqd,bhd->bhq", pq, z)[..., None] + 1e-6
        o = num / den
        return (lambda x, *d: x.permute(*d))(o, 0, 2, 1, 3).reshape(B, S, D) @ wo

    def _B_ref(x, w1, w3, w2):
        gate = torch.einsum("bsd,df->bsf", x, w1)
        up = torch.einsum("bsd,df->bsf", x, w3)
        h = _silu(gate) * up
        out = torch.einsum("bsf,fd->bsd", h, w2)
        return out

    x = A_x
    x = x + _A_ref(_layernorm(x, axis=-1), A_wqkv, A_wo)
    x = x + _B_ref(_layernorm(x, axis=-1), B_w1, B_w3, B_w2)
    x = x + _A_ref(_layernorm(x, axis=-1), A_wqkv, A_wo)
    x = x + _B_ref(_layernorm(x, axis=-1), B_w1, B_w3, B_w2)
    return x
```

```asm
; @launch grid=(256,1,1) block=(256,1,1) lds=163840
.amdgcn_target "amdgcn-amd-amdhsa--gfx950"
.text
.globl interleave_layers__linear_attn_block__glu_gated_swiglu__prompt_kernel
.p2align 8
.type interleave_layers__linear_attn_block__glu_gated_swiglu__prompt_kernel,@function
interleave_layers__linear_attn_block__glu_gated_swiglu__prompt_kernel:
  s_cmp_ge_u32 s2, 256
  s_cbranch_scc1 L_k1_end
  s_load_dwordx2 s[4:5], s[0:1], 72
  s_load_dwordx2 s[8:9], s[0:1], 56
  s_load_dwordx4 s[76:79], s[0:1], 0
  s_load_dwordx2 s[80:81], s[0:1], 16
  s_load_dwordx4 s[84:87], s[0:1], 32
  s_load_dwordx2 s[88:89], s[0:1], 48
  v_lshrrev_b32 v9, 6, v0
  v_and_b32 v0, 63, v0
  v_readfirstlane_b32 s12, v9
  s_getreg_b32 s19, hwreg(HW_REG_XCC_ID)
  s_and_b32 s19, s19, 7
  v_lshlrev_b32 v1, 4, v0
  v_lshlrev_b32 v6, 3, v0
  v_and_b32 v9, 31, v0
  v_lshlrev_b32 v7, 3, v9
  v_and_b32 v9, 15, v0
  v_lshlrev_b32 v8, 2, v9
  s_and_b32 s40, s2, 7
  s_lshr_b32 s41, s2, 3
  s_lshl_b32 s13, s40, 1
  s_lshr_b32 s42, s41, 4
  s_add_u32 s13, s13, s42
  s_and_b32 s14, s41, 15
  s_mov_b32 s15, 0
  s_mov_b32 s16, 0
  s_mov_b32 s18, 0
  s_mov_b32 s20, 0
  s_mov_b32 s21, 33792
  s_mov_b32 s22, 67584
  s_mov_b32 s23, 101376
  s_lshl_b32 s24, s12, 13
  s_lshr_b32 s34, s14, 3
  s_and_b32 s35, s14, 7
  s_and_b32 s32, s12, 1
  s_lshr_b32 s33, s12, 1
  s_lshl_b32 s36, s34, 1
  s_add_u32 s36, s36, s32
  s_mul_i32 s25, s14, 101376
  s_add_u32 s25, s25, 1048576
  s_lshl_b32 s26, s35, 16
  s_add_u32 s26, s26, 3145728
  s_mul_i32 s27, s14, 236544
  s_add_u32 s27, s27, 4194304
  s_mul_i32 s28, s35, 229376
  s_add_u32 s28, s28, 8388608
  s_lshl_b32 s29, s13, 17
  s_add_u32 s29, s29, 10485760
  s_lshl_b32 s30, s13, 14
  s_add_u32 s30, s30, 12582912
  s_lshl_b32 s37, s13, 7
  s_add_u32 s37, s37, 0
  v_mov_b32 v110, 0
  v_mov_b32 v111, 0
  v_mov_b32 v112, 0x3f803f80
  v_mov_b32 v113, 0x3f803f80
  v_mov_b32 v114, 0x3f803f80
  v_mov_b32 v115, 0x3f803f80
  s_waitcnt lgkmcnt(0)
  s_and_b32 s5, s5, 0xffff
  s_mov_b32 s6, 268435456
  s_mov_b32 s7, 0x20000
  v_mov_b32 v9, 28672
  buffer_load_dword v203, v9, s[4:7], 0 offen sc1
  s_and_b32 s9, s9, 0xffff
  s_mov_b32 s10, 2097152
  s_mov_b32 s11, 0x20000
  s_mov_b32 s72, s76
  s_and_b32 s73, s77, 0xffff
  s_mov_b32 s74, 2097152
  s_mov_b32 s75, 0x20000
  s_lshl_b32 s40, s13, 2
  s_add_u32 s40, s40, s36
  s_lshl_b32 s40, s40, 15
  s_lshl_b32 s41, s35, 7
  s_add_u32 s40, s40, s41
  s_lshl_b32 s41, s33, 6
  s_add_u32 s40, s40, s41
  v_and_b32 v134, 31, v0
  v_lshlrev_b32 v134, 10, v134
  v_lshrrev_b32 v135, 5, v0
  v_lshlrev_b32 v135, 3, v135
  v_add_u32 v134, v134, v135
  buffer_load_dwordx2 v[88:89], v134, s[72:75], s40 offen offset:0
  buffer_load_dwordx2 v[90:91], v134, s[72:75], s40 offen offset:16
  buffer_load_dwordx2 v[92:93], v134, s[72:75], s40 offen offset:32
  buffer_load_dwordx2 v[94:95], v134, s[72:75], s40 offen offset:48
  s_mov_b32 s67, 0x20000
  s_mov_b32 s71, 0x20000
  s_lshl_b32 s58, s12, 13
  s_add_u32 s58, s58, 67584
  s_mov_b32 s45, 0
  s_mov_b32 s49, 0
  s_cmp_ge_u32 s2, 232
  s_cbranch_scc1 L_p_none
  s_cmp_lt_u32 s2, 0
  s_cbranch_scc1 L_p_none
  s_mov_b32 s45, 1
  s_cmp_ge_u32 s2, 176
  s_cbranch_scc1 L_p_j2
  s_cmp_ge_u32 s2, 160
  s_cbranch_scc1 L_p_jo
  s_cmp_ge_u32 s2, 48
  s_cbranch_scc1 L_p_j13
  s_lshr_b32 s50, s2, 4
  s_lshr_b32 s51, s2, 1
  s_and_b32 s51, s51, 7
  s_and_b32 s52, s2, 1
  s_mov_b32 s64, s78
  s_and_b32 s65, s79, 0xffff
  s_mov_b32 s66, 1572864
  s_mov_b32 s41, 3072
  s_add_u32 s53, s50, 1
  s_cmp_eq_u32 s50, 2
  s_cselect_b32 s53, 0, s53
  s_lshl_b32 s53, s53, 10
  s_lshl_b32 s42, s51, 7
  s_add_u32 s42, s42, s53
  s_lshl_b32 s44, s52, 4
  s_lshl_b32 s53, s12, 2
  s_add_u32 s44, s44, s53
  s_mul_i32 s53, s51, 6
  s_add_u32 s53, s53, s50
  s_mul_i32 s46, s53, 33792
  s_add_u32 s46, s46, 1048576
  s_lshl_b32 s54, s44, 10
  s_add_u32 s46, s46, s54
  s_mov_b32 s47, 101376
  s_mov_b32 s60, 0
  s_mov_b32 s61, 1024
  s_mov_b32 s62, 2048
  s_mov_b32 s63, 3072
  s_lshl_b32 s49, s53, 9
  s_lshl_b32 s54, s52, 3
  s_add_u32 s49, s49, s54
  s_add_u32 s49, s49, 131072
  s_branch L_p_jobA
L_p_jo:
  s_sub_u32 s50, s2, 160
  s_lshr_b32 s51, s50, 1
  s_and_b32 s52, s50, 1
  s_mov_b32 s64, s80
  s_mov_b32 s65, s81
  s_and_b32 s65, s65, 0xffff
  s_mov_b32 s66, 524288
  s_mov_b32 s41, 1024
  s_lshl_b32 s42, s51, 7
  s_lshl_b32 s44, s52, 4
  s_lshl_b32 s53, s12, 2
  s_add_u32 s44, s44, s53
  s_lshl_b32 s46, s51, 16
  s_add_u32 s46, s46, 3145728
  s_lshl_b32 s54, s12, 4
  s_lshl_b32 s55, s52, 1
  s_add_u32 s54, s54, s55
  s_lshl_b32 s54, s54, 10
  s_add_u32 s46, s46, s54
  s_mov_b32 s47, 1024
  s_mov_b32 s60, 0
  s_mov_b32 s61, 4096
  s_mov_b32 s62, 8192
  s_mov_b32 s63, 12288
  s_branch L_p_jobA
L_p_j2:
  s_sub_u32 s50, s2, 176
  s_mul_i32 s51, s50, 9363
  s_lshr_b32 s51, s51, 16
  s_mul_i32 s52, s51, 7
  s_sub_u32 s52, s50, s52
  s_mov_b32 s64, s88
  s_mov_b32 s65, s89
  s_and_b32 s65, s65, 0xffff
  s_mov_b32 s66, 1835008
  s_mov_b32 s41, 1024
  s_lshl_b32 s42, s51, 7
  s_lshl_b32 s44, s52, 4
  s_lshl_b32 s53, s12, 2
  s_add_u32 s44, s44, s53
  s_cmp_ge_u32 s44, 56
  s_cselect_b32 s54, 56, 0
  s_cselect_b32 s55, 2, 0
  s_sub_u32 s54, s44, s54
  s_lshl_b32 s55, s55, 10
  s_mul_i32 s46, s51, 229376
  s_add_u32 s46, s46, s55
  s_add_u32 s46, s46, 8388608
  s_mov_b32 s47, 1024
  s_add_u32 s50, s54, 0
  s_lshl_b32 s60, s50, 12
  s_add_u32 s50, s54, 1
  s_lshl_b32 s61, s50, 12
  s_add_u32 s50, s54, 2
  s_lshl_b32 s62, s50, 12
  s_add_u32 s50, s54, 3
  s_lshl_b32 s63, s50, 12
L_p_jobA:
  v_lshrrev_b32 v136, 2, v0
  v_and_b32 v136, 7, v136
  v_mul_lo_u32 v136, v136, s41
  v_lshrrev_b32 v137, 5, v0
  v_lshlrev_b32 v137, 6, v137
  v_add_u32 v136, v136, v137
  v_and_b32 v137, 3, v0
  v_lshlrev_b32 v137, 4, v137
  v_add_u32 v136, v136, v137
  s_lshl_b32 s56, s41, 3
  s_mul_i32 s57, s44, s41
  s_lshl_b32 s57, s57, 4
  s_add_u32 s57, s57, s42
  s_add_u32 m0, s58, 0
  s_nop 0
  buffer_load_dwordx4 v136, s[64:67], s57 offen lds
  s_add_u32 s57, s57, s56
  s_add_u32 m0, s58, 1024
  s_nop 0
  buffer_load_dwordx4 v136, s[64:67], s57 offen lds
  s_add_u32 s57, s57, s56
  s_add_u32 m0, s58, 2048
  s_nop 0
  buffer_load_dwordx4 v136, s[64:67], s57 offen lds
  s_add_u32 s57, s57, s56
  s_add_u32 m0, s58, 3072
  s_nop 0
  buffer_load_dwordx4 v136, s[64:67], s57 offen lds
  s_add_u32 s57, s57, s56
  s_add_u32 m0, s58, 4096
  s_nop 0
  buffer_load_dwordx4 v136, s[64:67], s57 offen lds
  s_add_u32 s57, s57, s56
  s_add_u32 m0, s58, 5120
  s_nop 0
  buffer_load_dwordx4 v136, s[64:67], s57 offen lds
  s_add_u32 s57, s57, s56
  s_add_u32 m0, s58, 6144
  s_nop 0
  buffer_load_dwordx4 v136, s[64:67], s57 offen lds
  s_add_u32 s57, s57, s56
  s_add_u32 m0, s58, 7168
  s_nop 0
  buffer_load_dwordx4 v136, s[64:67], s57 offen lds
  s_branch L_p_none
L_p_j13:
  s_mov_b32 s45, 2
  s_sub_u32 s50, s2, 48
  s_lshr_b32 s51, s50, 2
  s_and_b32 s52, s50, 3
  s_mov_b32 s64, s84
  s_mov_b32 s68, s86
  s_mov_b32 s65, s85
  s_mov_b32 s69, s87
  s_and_b32 s65, s65, 0xffff
  s_mov_b32 s66, 1835008
  s_and_b32 s69, s69, 0xffff
  s_mov_b32 s70, 1835008
  s_lshl_b32 s44, s52, 3
  s_lshl_b32 s53, s12, 1
  s_add_u32 s44, s44, s53
  s_mul_i32 s46, s51, 135168
  s_add_u32 s46, s46, 4194304
  s_lshl_b32 s54, s44, 10
  s_add_u32 s46, s46, s54
  s_mov_b32 s47, 33792
  s_mov_b32 s60, 0
  s_mov_b32 s61, 1024
  s_lshl_b32 s49, s51, 2
  s_add_u32 s49, s49, 48
  s_add_u32 s49, s49, s12
  s_lshl_b32 s49, s49, 9
  s_lshl_b32 s54, s52, 2
  s_add_u32 s49, s49, s54
  s_add_u32 s49, s49, 131072
  v_lshrrev_b32 v136, 3, v0
  v_mul_u32_u24 v136, 3584, v136
  v_and_b32 v137, 7, v0
  v_lshlrev_b32 v137, 4, v137
  v_add_u32 v136, v136, v137
  s_mul_i32 s57, s44, 57344
  s_lshl_b32 s54, s51, 7
  s_add_u32 s57, s57, s54
  s_mov_b32 s59, s57
  s_add_u32 m0, s58, 0
  s_nop 0
  buffer_load_dwordx4 v136, s[64:67], s59 offen lds
  s_add_u32 s59, s59, 28672
  s_add_u32 m0, s58, 1024
  s_nop 0
  buffer_load_dwordx4 v136, s[64:67], s59 offen lds
  s_add_u32 s59, s59, 28672
  s_add_u32 m0, s58, 2048
  s_nop 0
  buffer_load_dwordx4 v136, s[64:67], s59 offen lds
  s_add_u32 s59, s59, 28672
  s_add_u32 m0, s58, 3072
  s_nop 0
  buffer_load_dwordx4 v136, s[64:67], s59 offen lds
  s_mov_b32 s59, s57
  s_add_u32 m0, s58, 4096
  s_nop 0
  buffer_load_dwordx4 v136, s[68:71], s59 offen lds
  s_add_u32 s59, s59, 28672
  s_add_u32 m0, s58, 5120
  s_nop 0
  buffer_load_dwordx4 v136, s[68:71], s59 offen lds
  s_add_u32 s59, s59, 28672
  s_add_u32 m0, s58, 6144
  s_nop 0
  buffer_load_dwordx4 v136, s[68:71], s59 offen lds
  s_add_u32 s59, s59, 28672
  s_add_u32 m0, s58, 7168
  s_nop 0
  buffer_load_dwordx4 v136, s[68:71], s59 offen lds
L_p_none:
  v_lshrrev_b32 v139, 5, v0
  v_lshlrev_b32 v139, 2, v139
  v_and_b32 v137, 15, v0
  v_lshrrev_b32 v137, 2, v137
  v_add_u32 v139, v139, v137
  v_lshrrev_b32 v137, 4, v0
  v_and_b32 v137, 1, v137
  v_and_b32 v135, 3, v0
  v_lshlrev_b32 v135, 3, v135
  v_lshlrev_b32 v138, 6, v139
  v_lshlrev_b32 v134, 5, v137
  v_add_u32 v138, v138, v134
  v_add_u32 v138, v138, v135
  v_add_u32 v138, s58, v138
  v_lshlrev_b32 v139, 7, v139
  v_lshlrev_b32 v134, 12, v137
  v_add_u32 v139, v139, v134
  v_add_u32 v139, v139, v135
  v_add_u32 v139, s58, v139
  s_lshl_b32 s40, s13, 2
  s_add_u32 s40, s40, s36
  s_lshl_b32 s50, s40, 12
  s_lshl_b32 s40, s40, 15
  s_lshl_b32 s51, s35, 2
  s_lshl_b32 s52, s33, 1
  s_add_u32 s51, s51, s52
  s_lshl_b32 s51, s51, 10
  s_add_u32 s40, s40, s51
  s_add_u32 s40, s40, 10485760
  s_lshr_b32 s51, s35, 1
  s_lshl_b32 s51, s51, 10
  s_add_u32 s50, s50, s51
  s_and_b32 s51, s35, 1
  s_lshl_b32 s51, s51, 9
  s_add_u32 s50, s50, s51
  s_lshl_b32 s51, s33, 3
  s_add_u32 s50, s50, s51
  s_add_u32 s50, s50, 12582912
  v_lshlrev_b32 v156, 1, v7
  v_lshlrev_b32 v157, 2, v0
  s_cmp_eq_u32 s45, 0
  s_cbranch_scc1 xw___prompt_1
  s_waitcnt vmcnt(8)
  s_branch xw2___prompt_2
xw___prompt_1:
  s_waitcnt vmcnt(0)
xw2___prompt_2:
  v_readfirstlane_b32 s39, v203
  buffer_store_dwordx4 v[88:91], v1, s[4:7], s40 offen sc1
  buffer_store_dwordx4 v[92:95], v1, s[4:7], s40 offen offset:1024 sc1
  v_lshlrev_b32 v140, 16, v88
  v_and_b32 v141, 0xffff0000, v88
  v_lshlrev_b32 v142, 16, v89
  v_and_b32 v143, 0xffff0000, v89
  v_lshlrev_b32 v144, 16, v90
  v_and_b32 v145, 0xffff0000, v90
  v_lshlrev_b32 v146, 16, v91
  v_and_b32 v147, 0xffff0000, v91
  v_lshlrev_b32 v148, 16, v92
  v_and_b32 v149, 0xffff0000, v92
  v_lshlrev_b32 v150, 16, v93
  v_and_b32 v151, 0xffff0000, v93
  v_lshlrev_b32 v152, 16, v94
  v_and_b32 v153, 0xffff0000, v94
  v_lshlrev_b32 v154, 16, v95
  v_and_b32 v155, 0xffff0000, v95
  v_add_f32 v200, v140, v144
  v_add_f32 v196, v141, v145
  v_add_f32 v197, v142, v146
  v_add_f32 v198, v143, v147
  v_add_f32 v200, v200, v148
  v_add_f32 v196, v196, v149
  v_add_f32 v197, v197, v150
  v_add_f32 v198, v198, v151
  v_add_f32 v200, v200, v152
  v_add_f32 v196, v196, v153
  v_add_f32 v197, v197, v154
  v_add_f32 v198, v198, v155
  v_add_f32 v200, v200, v196
  v_add_f32 v197, v197, v198
  s_nop 0
  v_add_f32 v200, v200, v197
  s_nop 0
  v_mov_b32 v196, v200
  s_nop 1
  v_permlane32_swap_b32 v200, v196
  s_nop 0
  v_add_f32 v200, v200, v196
  s_nop 0
  v_mul_f32 v199, 0xbd000000, v200
  s_nop 0
  v_add_f32 v140, v140, v199
  v_add_f32 v141, v141, v199
  v_add_f32 v142, v142, v199
  v_add_f32 v143, v143, v199
  v_add_f32 v144, v144, v199
  v_add_f32 v145, v145, v199
  v_add_f32 v146, v146, v199
  v_add_f32 v147, v147, v199
  v_add_f32 v148, v148, v199
  v_add_f32 v149, v149, v199
  v_add_f32 v150, v150, v199
  v_add_f32 v151, v151, v199
  v_add_f32 v152, v152, v199
  v_add_f32 v153, v153, v199
  v_add_f32 v154, v154, v199
  v_add_f32 v155, v155, v199
  v_mul_f32 v201, v140, v140
  v_mul_f32 v196, v141, v141
  v_mul_f32 v197, v142, v142
  v_mul_f32 v198, v143, v143
  v_fmac_f32 v201, v144, v144
  v_fmac_f32 v196, v145, v145
  v_fmac_f32 v197, v146, v146
  v_fmac_f32 v198, v147, v147
  v_fmac_f32 v201, v148, v148
  v_fmac_f32 v196, v149, v149
  v_fmac_f32 v197, v150, v150
  v_fmac_f32 v198, v151, v151
  v_fmac_f32 v201, v152, v152
  v_fmac_f32 v196, v153, v153
  v_fmac_f32 v197, v154, v154
  v_fmac_f32 v198, v155, v155
  v_add_f32 v201, v201, v196
  v_add_f32 v197, v197, v198
  s_nop 0
  v_add_f32 v201, v201, v197
  s_nop 0
  v_mov_b32 v196, v201
  s_nop 1
  v_permlane32_swap_b32 v201, v196
  s_nop 0
  v_add_f32 v201, v201, v196
  buffer_store_dwordx2 v[200:201], v156, s[4:7], s50 offen sc1
  s_waitcnt vmcnt(3)
  s_cmp_eq_u32 s45, 0
  s_cbranch_scc1 L_p_now
  s_cmp_eq_u32 s45, 2
  s_cbranch_scc1 L_p_fB
  ds_read_b64_tr_b16 v[164:165], v138 offset:0
  ds_read_b64_tr_b16 v[166:167], v138 offset:1024
  ds_read_b64_tr_b16 v[168:169], v138 offset:2048
  ds_read_b64_tr_b16 v[170:171], v138 offset:3072
  ds_read_b64_tr_b16 v[172:173], v138 offset:4096
  ds_read_b64_tr_b16 v[174:175], v138 offset:5120
  ds_read_b64_tr_b16 v[176:177], v138 offset:6144
  ds_read_b64_tr_b16 v[178:179], v138 offset:7168
  ds_read_b64_tr_b16 v[180:181], v138 offset:512
  ds_read_b64_tr_b16 v[182:183], v138 offset:1536
  ds_read_b64_tr_b16 v[184:185], v138 offset:2560
  ds_read_b64_tr_b16 v[186:187], v138 offset:3584
  ds_read_b64_tr_b16 v[188:189], v138 offset:4608
  ds_read_b64_tr_b16 v[190:191], v138 offset:5632
  s_waitcnt lgkmcnt(6)
  ds_read_b64_tr_b16 v[192:193], v138 offset:6656
  ds_read_b64_tr_b16 v[194:195], v138 offset:7680
  s_waitcnt lgkmcnt(0)
  s_mul_i32 s51, s47, 0
  s_add_u32 s51, s51, s60
  s_add_u32 s51, s51, s46
  buffer_store_dwordx4 v[164:167], v1, s[4:7], s51 offen sc1
  v_mfma_f32_32x32x16_bf16 v[16:31], v[112:115], v[164:167], 0
  s_mul_i32 s51, s47, 0
  s_add_u32 s51, s51, s61
  s_add_u32 s51, s51, s46
  buffer_store_dwordx4 v[168:171], v1, s[4:7], s51 offen sc1
  v_mfma_f32_32x32x16_bf16 v[16:31], v[112:115], v[168:171], v[16:31]
  s_mul_i32 s51, s47, 0
  s_add_u32 s51, s51, s62
  s_add_u32 s51, s51, s46
  buffer_store_dwordx4 v[172:175], v1, s[4:7], s51 offen sc1
  v_mfma_f32_32x32x16_bf16 v[16:31], v[112:115], v[172:175], v[16:31]
  s_mul_i32 s51, s47, 0
  s_add_u32 s51, s51, s63
  s_add_u32 s51, s51, s46
  buffer_store_dwordx4 v[176:179], v1, s[4:7], s51 offen sc1
  v_mfma_f32_32x32x16_bf16 v[16:31], v[112:115], v[176:179], v[16:31]
  s_mul_i32 s51, s47, 1
  s_add_u32 s51, s51, s60
  s_add_u32 s51, s51, s46
  buffer_store_dwordx4 v[180:183], v1, s[4:7], s51 offen sc1
  v_mfma_f32_32x32x16_bf16 v[32:47], v[112:115], v[180:183], 0
  s_mul_i32 s51, s47, 1
  s_add_u32 s51, s51, s61
  s_add_u32 s51, s51, s46
  buffer_store_dwordx4 v[184:187], v1, s[4:7], s51 offen sc1
  v_mfma_f32_32x32x16_bf16 v[32:47], v[112:115], v[184:187], v[32:47]
  s_mul_i32 s51, s47, 1
  s_add_u32 s51, s51, s62
  s_add_u32 s51, s51, s46
  buffer_store_dwordx4 v[188:191], v1, s[4:7], s51 offen sc1
  v_mfma_f32_32x32x16_bf16 v[32:47], v[112:115], v[188:191], v[32:47]
  s_mul_i32 s51, s47, 1
  s_add_u32 s51, s51, s63
  s_add_u32 s51, s51, s46
  buffer_store_dwordx4 v[192:195], v1, s[4:7], s51 offen sc1
  v_mfma_f32_32x32x16_bf16 v[32:47], v[112:115], v[192:195], v[32:47]
  s_nop 15
  s_lshl_b32 s59, s12, 8
  v_add_u32 v158, s59, v157
  v_add_u32 v158, 136192, v158
  ds_write_b32 v158, v16 offset:0
  ds_write_b32 v158, v32 offset:1024
  s_waitcnt lgkmcnt(0)
  s_branch L_p_now
L_p_fB:
  ds_read_b64_tr_b16 v[164:165], v139 offset:0
  ds_read_b64_tr_b16 v[166:167], v139 offset:1024
  ds_read_b64_tr_b16 v[168:169], v139 offset:2048
  ds_read_b64_tr_b16 v[170:171], v139 offset:3072
  ds_read_b64_tr_b16 v[172:173], v139 offset:32
  ds_read_b64_tr_b16 v[174:175], v139 offset:1056
  ds_read_b64_tr_b16 v[176:177], v139 offset:2080
  ds_read_b64_tr_b16 v[178:179], v139 offset:3104
  ds_read_b64_tr_b16 v[180:181], v139 offset:64
  ds_read_b64_tr_b16 v[182:183], v139 offset:1088
  ds_read_b64_tr_b16 v[184:185], v139 offset:2112
  ds_read_b64_tr_b16 v[186:187], v139 offset:3136
  ds_read_b64_tr_b16 v[188:189], v139 offset:96
  ds_read_b64_tr_b16 v[190:191], v139 offset:1120
  s_waitcnt lgkmcnt(6)
  ds_read_b64_tr_b16 v[192:193], v139 offset:2144
  ds_read_b64_tr_b16 v[194:195], v139 offset:3168
  s_waitcnt lgkmcnt(0)
  s_mul_i32 s51, s47, 0
  s_add_u32 s51, s51, s60
  s_add_u32 s51, s51, s46
  buffer_store_dwordx4 v[164:167], v1, s[4:7], s51 offen sc1
  v_mfma_f32_32x32x16_bf16 v[16:31], v[112:115], v[164:167], 0
  s_mul_i32 s51, s47, 0
  s_add_u32 s51, s51, s61
  s_add_u32 s51, s51, s46
  buffer_store_dwordx4 v[168:171], v1, s[4:7], s51 offen sc1
  v_mfma_f32_32x32x16_bf16 v[16:31], v[112:115], v[168:171], v[16:31]
  s_mul_i32 s51, s47, 1
  s_add_u32 s51, s51, s60
  s_add_u32 s51, s51, s46
  buffer_store_dwordx4 v[172:175], v1, s[4:7], s51 offen sc1
  v_mfma_f32_32x32x16_bf16 v[32:47], v[112:115], v[172:175], 0
  s_mul_i32 s51, s47, 1
  s_add_u32 s51, s51, s61
  s_add_u32 s51, s51, s46
  buffer_store_dwordx4 v[176:179], v1, s[4:7], s51 offen sc1
  v_mfma_f32_32x32x16_bf16 v[32:47], v[112:115], v[176:179], v[32:47]
  s_mul_i32 s51, s47, 2
  s_add_u32 s51, s51, s60
  s_add_u32 s51, s51, s46
  buffer_store_dwordx4 v[180:183], v1, s[4:7], s51 offen sc1
  v_mfma_f32_32x32x16_bf16 v[48:63], v[112:115], v[180:183], 0
  s_mul_i32 s51, s47, 2
  s_add_u32 s51, s51, s61
  s_add_u32 s51, s51, s46
  buffer_store_dwordx4 v[184:187], v1, s[4:7], s51 offen sc1
  v_mfma_f32_32x32x16_bf16 v[48:63], v[112:115], v[184:187], v[48:63]
  s_mul_i32 s51, s47, 3
  s_add_u32 s51, s51, s60
  s_add_u32 s51, s51, s46
  buffer_store_dwordx4 v[188:191], v1, s[4:7], s51 offen sc1
  v_mfma_f32_32x32x16_bf16 v[140:155], v[112:115], v[188:191], 0
  s_mul_i32 s51, s47, 3
  s_add_u32 s51, s51, s61
  s_add_u32 s51, s51, s46
  buffer_store_dwordx4 v[192:195], v1, s[4:7], s51 offen sc1
  v_mfma_f32_32x32x16_bf16 v[140:155], v[112:115], v[192:195], v[140:155]
  s_nop 15
  s_lshl_b32 s59, s12, 8
  v_add_u32 v158, s59, v157
  v_add_u32 v158, 136192, v158
  ds_write_b32 v158, v16 offset:0
  ds_write_b32 v158, v32 offset:1024
  ds_write_b32 v158, v48 offset:2048
  ds_write_b32 v158, v140 offset:3072
  s_waitcnt lgkmcnt(0)
L_p_now:
  s_barrier
  s_cmp_eq_u32 s49, 0
  s_cbranch_scc1 L_p_noaug
  s_cmp_eq_u32 s45, 2
  s_cbranch_scc1 L_p_augB
  s_cmp_ge_u32 s12, 2
  s_cbranch_scc1 L_p_noaug
  s_lshl_b32 s59, s12, 10
  s_mul_i32 s51, s12, 1536
  s_add_u32 s49, s49, s51
  s_branch L_p_augC
L_p_augB:
  s_lshl_b32 s59, s12, 10
L_p_augC:
  v_add_u32 v158, s59, v157
  v_add_u32 v158, 136192, v158
  ds_read_b32 v159, v158
  ds_read_b32 v160, v158 offset:256
  ds_read_b32 v161, v158 offset:512
  ds_read_b32 v162, v158 offset:768
  s_waitcnt lgkmcnt(0)
  v_add_f32 v159, v159, v160
  v_add_f32 v161, v161, v162
  v_add_f32 v160, v159, v161
  v_mov_b32 v161, 0
  s_cmp_eq_u32 s45, 2
  s_cbranch_scc1 L_p_augD
  buffer_store_dwordx2 v[160:161], v156, s[4:7], s49 offen sc1
  s_branch L_p_noaug
L_p_augD:
  buffer_store_dword v160, v156, s[4:7], s49 offen sc1
L_p_noaug:
  s_add_u32 s39, s39, 1
  s_mul_i32 s38, s39, 0x9e3779b1
  s_and_b32 s38, s38, 0xfffffff0
  s_and_b32 s55, s13, 1
  s_lshl_b32 s56, s55, 1
  s_add_u32 s56, s56, s34
  s_mov_b32 s94, -1
  s_mov_b32 s95, -1
  s_mul_i32 s53, s33, 3072
  s_lshl_b32 s54, s33, 10
  s_add_u32 s54, s54, 1024
  v_add_u32 v2, s20, v1
  v_add_u32 v3, s21, v1
  v_add_u32 v4, s22, v1
  v_add_u32 v5, s23, v1
  s_lshl_b32 s45, s12, 8
  s_add_u32 s45, s45, 135168
  v_lshrrev_b32 v9, 1, v7
  v_add_u32 v64, s45, v9
  v_lshrrev_b32 v10, 5, v0
  v_lshlrev_b32 v9, 4, v10
  v_add_u32 v65, s45, v9
  s_mul_i32 s45, s12, 2304
  s_add_u32 s45, s45, 136192
  v_and_b32 v9, 15, v0
  v_lshlrev_b32 v11, 4, v10
  v_add_u32 v9, v9, v11
  v_lshlrev_b32 v9, 5, v9
  v_and_b32 v11, 16, v0
  v_lshlrev_b32 v12, 6, v11
  v_add_u32 v12, v9, v12
  v_add_u32 v66, s45, v12
  v_lshlrev_b32 v12, 5, v10
  v_add_u32 v67, s45, v12
  v_add_u32 v12, 2048, v12
  v_cmp_eq_u32 vcc, 0, v11
  v_add_u32 v13, 1024, v9
  v_add_u32 v14, 64, v12
  v_cndmask_b32 v9, v12, v9, vcc
  v_cndmask_b32 v13, v14, v13, vcc
  v_add_u32 v69, 145408, v9
  v_add_u32 v70, 145408, v13
  s_lshl_b32 s45, s12, 10
  v_add_u32 v68, s45, v1
  s_lshl_b32 s45, s12, 12
  s_add_u32 s45, s45, 136192
  v_add_u32 v71, s45, v1
  s_xor_b32 s46, s12, 2
  s_lshl_b32 s46, s46, 12
  s_add_u32 s46, s46, 136192
  v_add_u32 v72, s46, v1
  v_lshlrev_b32 v73, 2, v0
  v_lshlrev_b32 v7, 1, v7
  s_lshl_b32 s44, s13, 2
  s_add_u32 s44, s44, s36
  s_lshl_b32 s47, s44, 12
  s_lshl_b32 s44, s44, 15
  s_lshl_b32 s45, s35, 2
  s_lshl_b32 s46, s33, 1
  s_add_u32 s45, s45, s46
  s_lshl_b32 s45, s45, 10
  s_add_u32 s82, s44, s45
  s_add_u32 s82, s82, 10485760
  s_lshr_b32 s45, s35, 1
  s_lshl_b32 s45, s45, 10
  s_add_u32 s47, s47, s45
  s_and_b32 s45, s35, 1
  s_lshl_b32 s45, s45, 9
  s_add_u32 s47, s47, s45
  s_lshl_b32 s45, s33, 3
  s_add_u32 s83, s47, s45
  s_add_u32 s83, s83, 12582912
  s_lshl_b32 s45, s35, 7
  s_add_u32 s90, s44, s45
  s_lshl_b32 s45, s33, 6
  s_add_u32 s90, s90, s45
  s_lshl_b32 s44, s13, 17
  s_lshl_b32 s45, s12, 15
  s_add_u32 s44, s44, s45
  s_lshl_b32 s45, s14, 11
  s_add_u32 s44, s44, s45
  s_add_u32 s84, s44, 16777216
  s_lshl_b32 s44, s13, 2
  s_add_u32 s44, s44, s12
  s_mul_i32 s44, s44, 114688
  s_mul_i32 s45, s14, 7168
  s_add_u32 s44, s44, s45
  s_add_u32 s85, s44, 25165824
  s_mul_i32 s87, s14, 36864
  s_add_u32 s87, s87, 24379392
  s_mul_i32 s45, s13, 2304
  s_add_u32 s86, s87, s45
  s_lshl_b32 s89, s14, 8
  s_add_u32 s89, s89, 8192
  s_lshl_b32 s45, s13, 2
  s_add_u32 s45, s45, s12
  s_lshl_b32 s45, s45, 2
  s_add_u32 s88, s89, s45
  s_mov_b32 s17, s38
  s_add_u32 s19, s19, s38
  s_add_u32 s19, s19, 1
  s_waitcnt vmcnt(0)
  s_barrier
  s_cmp_lg_u32 s12, 0
  s_cbranch_scc1 pp___prompt_3
  s_lshl_b32 s45, s13, 7
  s_lshl_b32 s46, s14, 2
  s_add_u32 s45, s45, s46
  s_add_u32 s45, s45, 4096
  s_lshl_b32 s46, s2, 6
  s_add_u32 s46, s46, 32768
  v_mov_b32 v10, s19
  v_mov_b32 v11, 0
  s_add_u32 s47, s38, 1
  v_mov_b32 v12, s47
  s_mov_b64 exec, 1
  buffer_store_dword v10, v11, s[4:7], s45 offen sc1
  buffer_store_dword v12, v11, s[4:7], s46 offen sc1
  s_mov_b64 exec, -1
  s_lshl_b32 s45, s13, 7
  s_add_u32 s45, s45, 4096
  v_lshlrev_b32 v13, 2, v0
  v_add_u32 v13, s45, v13
  v_subrev_u32 v15, 16, v0
  v_lshrrev_b32 v14, 1, v15
  v_lshlrev_b32 v14, 4, v14
  v_and_b32 v15, 1, v15
  v_add_u32 v14, v14, v15
  s_lshr_b32 s45, s14, 1
  s_lshl_b32 s45, s45, 1
  v_add_u32 v14, s45, v14
  s_lshl_b32 s45, s35, 1
  s_add_u32 s45, s45, 160-22
  v_add_u32 v15, s45, v0
  v_cmp_le_u32 vcc, 22, v0
  s_nop 1
  v_cndmask_b32 v14, v14, v15, vcc
  s_mul_i32 s45, s14, 7
  s_lshr_b32 s45, s45, 2
  s_lshl_b32 s45, s45, 2
  s_add_u32 s45, s45, 48-24
  v_add_u32 v15, s45, v0
  v_min_u32 v15, 159, v15
  v_cmp_le_u32 vcc, 24, v0
  s_nop 1
  v_cndmask_b32 v14, v14, v15, vcc
  s_mul_i32 s45, s35, 7
  s_add_u32 s45, s45, 176-36
  v_add_u32 v15, s45, v0
  v_cmp_le_u32 vcc, 36, v0
  s_nop 1
  v_cndmask_b32 v14, v14, v15, vcc
  v_lshlrev_b32 v14, 6, v14
  v_add_u32 v14, 32768, v14
  v_cmp_le_u32 vcc, 16, v0
  s_nop 1
  v_cndmask_b32 v13, v13, v14, vcc
  s_mov_b32 s62, -1
  s_mov_b32 s63, 0x7ff
  s_mov_b64 exec, s[62:63]
  s_mov_b32 s46, 0
ppl___prompt_4:
  s_add_u32 s46, s46, 1
  s_cmp_gt_u32 s46, 4194304
  s_cbranch_scc1 ppt___prompt_5
  buffer_load_dword v9, v13, s[4:7], 0 offen sc1
  s_waitcnt vmcnt(0)
  v_subrev_u32 v10, s47, v9
  v_cmp_le_u32 vcc, 8, v10
  s_cbranch_vccz ppx___prompt_6
  s_branch ppl___prompt_4
ppt___prompt_5:
  s_mov_b32 s18, 4
ppx___prompt_6:
  s_mov_b32 s62, 0xffff
  s_mov_b32 s63, 0
  s_mov_b64 exec, s[62:63]
  v_cmp_ne_u32 vcc, s19, v9
  s_mov_b64 exec, -1
  s_cmp_lg_u64 vcc, 0
  s_cselect_b32 s47, 1, 0
  v_mov_b32 v10, s47
  v_mov_b32 v11, 147648
  ds_write_b32 v11, v10
  s_waitcnt lgkmcnt(0)
pp___prompt_3:
  s_barrier
  v_mov_b32 v11, 147648
  ds_read_b32 v10, v11
  s_waitcnt lgkmcnt(0)
  v_readfirstlane_b32 s16, v10
  v_and_b32 v9, 31, v0
  v_lshlrev_b32 v9, 4, v9
  s_mul_i32 s44, s14, 1536
  s_add_u32 s44, s44, 131072
  buffer_load_dwordx4 v[132:135], v9, s[4:7], s44 offen offset:0
  buffer_load_dwordx4 v[136:139], v9, s[4:7], s44 offen offset:512
  buffer_load_dwordx4 v[140:143], v9, s[4:7], s44 offen offset:1024
  s_mul_i32 s44, s14, 3584
  s_add_u32 s44, s44, 155648
  buffer_load_dwordx4 v[144:147], v9, s[4:7], s44 offen offset:0
  buffer_load_dwordx4 v[148:151], v9, s[4:7], s44 offen offset:512
  buffer_load_dwordx4 v[152:155], v9, s[4:7], s44 offen offset:1024
  buffer_load_dwordx4 v[156:159], v9, s[4:7], s44 offen offset:1536
  buffer_load_dwordx4 v[160:163], v9, s[4:7], s44 offen offset:2048
  buffer_load_dwordx4 v[164:167], v9, s[4:7], s44 offen offset:2560
  buffer_load_dwordx4 v[168:171], v9, s[4:7], s44 offen offset:3072
  s_add_u32 s40, s20, s24
  s_add_u32 s41, s25, s24
  s_mov_b32 m0, s40
  s_nop 0
  buffer_load_dwordx4 v1, s[4:7], s41 offen offset:0 lds
  buffer_load_dwordx4 v1, s[4:7], s41 offen offset:1024 lds
  buffer_load_dwordx4 v1, s[4:7], s41 offen offset:2048 lds
  buffer_load_dwordx4 v1, s[4:7], s41 offen offset:3072 lds
  s_add_u32 m0, s40, 4096
  s_add_u32 s41, s41, 4096
  buffer_load_dwordx4 v1, s[4:7], s41 offen offset:0 lds
  buffer_load_dwordx4 v1, s[4:7], s41 offen offset:1024 lds
  buffer_load_dwordx4 v1, s[4:7], s41 offen offset:2048 lds
  buffer_load_dwordx4 v1, s[4:7], s41 offen offset:3072 lds
  s_add_u32 s40, s21, s24
  s_add_u32 s41, s25, s24
  s_add_u32 s41, s41, 33792
  s_mov_b32 m0, s40
  s_nop 0
  buffer_load_dwordx4 v1, s[4:7], s41 offen offset:0 lds
  buffer_load_dwordx4 v1, s[4:7], s41 offen offset:1024 lds
  buffer_load_dwordx4 v1, s[4:7], s41 offen offset:2048 lds
  buffer_load_dwordx4 v1, s[4:7], s41 offen offset:3072 lds
  s_add_u32 m0, s40, 4096
  s_add_u32 s41, s41, 4096
  buffer_load_dwordx4 v1, s[4:7], s41 offen offset:0 lds
  buffer_load_dwordx4 v1, s[4:7], s41 offen offset:1024 lds
  buffer_load_dwordx4 v1, s[4:7], s41 offen offset:2048 lds
  buffer_load_dwordx4 v1, s[4:7], s41 offen offset:3072 lds
  v_mov_b32 v86, 0
  v_mov_b32 v87, 0
  v_mov_b32 v206, 0
  v_mov_b32 v207, 0
L_k1_layer:
  s_lshl_b32 s44, s12, 15
  s_add_u32 s44, s44, s29
  buffer_load_dwordx4 a[0:3], v1, s[4:7], s44 offen offset:0 sc1
  buffer_load_dwordx4 a[4:7], v1, s[4:7], s44 offen offset:1024 sc1
  buffer_load_dwordx4 a[8:11], v1, s[4:7], s44 offen offset:2048 sc1
  buffer_load_dwordx4 a[12:15], v1, s[4:7], s44 offen offset:3072 sc1
  s_lshl_b32 s52, s12, 12
  s_add_u32 s52, s52, s30
  buffer_load_dwordx4 v[116:119], v1, s[4:7], s52 offen offset:0 sc1
  buffer_load_dwordx4 v[120:123], v1, s[4:7], s52 offen offset:1024 sc1
  buffer_load_dwordx4 v[124:127], v1, s[4:7], s52 offen offset:2048 sc1
  buffer_load_dwordx4 v[128:131], v1, s[4:7], s52 offen offset:3072 sc1
  s_add_u32 s44, s44, 4096
  buffer_load_dwordx4 a[16:19], v1, s[4:7], s44 offen offset:0 sc1
  buffer_load_dwordx4 a[20:23], v1, s[4:7], s44 offen offset:1024 sc1
  buffer_load_dwordx4 a[24:27], v1, s[4:7], s44 offen offset:2048 sc1
  buffer_load_dwordx4 a[28:31], v1, s[4:7], s44 offen offset:3072 sc1
  s_add_u32 s44, s44, 4096
  buffer_load_dwordx4 a[32:35], v1, s[4:7], s44 offen offset:0 sc1
  buffer_load_dwordx4 a[36:39], v1, s[4:7], s44 offen offset:1024 sc1
  s_cmp_lg_u32 s15, 0
  s_cbranch_scc1 aug___prompt_7
  s_waitcnt vmcnt(30)
  v_add_f32 v132, v132, v133
  v_add_f32 v134, v134, v135
  v_add_f32 v136, v136, v137
  v_add_f32 v138, v138, v139
  v_add_f32 v140, v140, v141
  v_add_f32 v142, v142, v143
  v_add_f32 v144, v144, v145
  v_add_f32 v146, v146, v147
  v_add_f32 v148, v148, v149
  v_add_f32 v150, v150, v151
  v_add_f32 v152, v152, v153
  v_add_f32 v154, v154, v155
  v_add_f32 v156, v156, v157
  v_add_f32 v158, v158, v159
  v_add_f32 v160, v160, v161
  v_add_f32 v162, v162, v163
  v_add_f32 v164, v164, v165
  v_add_f32 v166, v166, v167
  v_add_f32 v168, v168, v169
  v_add_f32 v170, v170, v171
  v_add_f32 v132, v132, v134
  v_add_f32 v136, v136, v138
  v_add_f32 v140, v140, v142
  v_add_f32 v144, v144, v146
  v_add_f32 v148, v148, v150
  v_add_f32 v152, v152, v154
  v_add_f32 v156, v156, v158
  v_add_f32 v160, v160, v162
  v_add_f32 v164, v164, v166
  v_add_f32 v168, v168, v170
  v_cvt_pk_bf16_f32 v133, v132, v132
  v_cvt_pk_bf16_f32 v137, v136, v136
  v_cvt_pk_bf16_f32 v141, v140, v140
  v_cvt_pk_bf16_f32 v145, v144, v144
  v_cvt_pk_bf16_f32 v149, v148, v148
  v_cvt_pk_bf16_f32 v153, v152, v152
  v_cvt_pk_bf16_f32 v157, v156, v156
  v_cvt_pk_bf16_f32 v161, v160, v160
  v_cvt_pk_bf16_f32 v165, v164, v164
  v_cvt_pk_bf16_f32 v169, v168, v168
  v_lshlrev_b32 v133, 16, v133
  v_lshlrev_b32 v137, 16, v137
  v_lshlrev_b32 v141, 16, v141
  v_lshlrev_b32 v145, 16, v145
  v_lshlrev_b32 v149, 16, v149
  v_lshlrev_b32 v153, 16, v153
  v_lshlrev_b32 v157, 16, v157
  v_lshlrev_b32 v161, 16, v161
  v_lshlrev_b32 v165, 16, v165
  v_lshlrev_b32 v169, 16, v169
  v_sub_f32 v133, v132, v133
  v_sub_f32 v137, v136, v137
  v_sub_f32 v141, v140, v141
  v_sub_f32 v145, v144, v145
  v_sub_f32 v149, v148, v149
  v_sub_f32 v153, v152, v153
  v_sub_f32 v157, v156, v157
  v_sub_f32 v161, v160, v161
  v_sub_f32 v165, v164, v165
  v_sub_f32 v169, v168, v169
  v_cmp_gt_u32 vcc, 32, v0
  v_cvt_pk_bf16_f32 v132, v132, v133
  v_cvt_pk_bf16_f32 v136, v136, v137
  v_cvt_pk_bf16_f32 v140, v140, v141
  v_cvt_pk_bf16_f32 v144, v144, v145
  v_cvt_pk_bf16_f32 v148, v148, v149
  v_cvt_pk_bf16_f32 v152, v152, v153
  v_cvt_pk_bf16_f32 v156, v156, v157
  v_cvt_pk_bf16_f32 v160, v160, v161
  v_cvt_pk_bf16_f32 v164, v164, v165
  v_cvt_pk_bf16_f32 v168, v168, v169
  v_cndmask_b32 v74, 0, v132, vcc
  v_cndmask_b32 v75, 0, v136, vcc
  v_cndmask_b32 v76, 0, v140, vcc
  v_cndmask_b32 v77, 0, v144, vcc
  v_cndmask_b32 v78, 0, v148, vcc
  v_cndmask_b32 v79, 0, v152, vcc
  v_cndmask_b32 v80, 0, v156, vcc
  v_cndmask_b32 v81, 0, v160, vcc
  v_cndmask_b32 v82, 0, v164, vcc
  v_cndmask_b32 v83, 0, v168, vcc
aug___prompt_7:
  s_waitcnt vmcnt(14)
  s_barrier
  ds_read_b128 v[208:211], v2 offset:0
  ds_read_b128 v[212:215], v3 offset:0
  ds_read_b128 v[216:219], v2 offset:1024
  ds_read_b128 v[220:223], v3 offset:1024
  s_waitcnt vmcnt(13) lgkmcnt(2)
  v_mfma_f32_32x32x16_bf16 v[16:31], a[0:3], v[208:211], 0
  ds_read_b128 v[224:227], v2 offset:2048
  v_mfma_f32_32x32x16_bf16 v[32:47], a[0:3], v[212:215], 0
  ds_read_b128 v[228:231], v3 offset:2048
  buffer_load_dwordx4 a[40:43], v1, s[4:7], s44 offen offset:2048 sc1
  s_waitcnt vmcnt(13) lgkmcnt(2)
  v_mfma_f32_32x32x16_bf16 v[16:31], a[4:7], v[216:219], v[16:31]
  ds_read_b128 v[208:211], v2 offset:3072
  v_mfma_f32_32x32x16_bf16 v[32:47], a[4:7], v[220:223], v[32:47]
  ds_read_b128 v[212:215], v3 offset:3072
  buffer_load_dwordx4 a[44:47], v1, s[4:7], s44 offen offset:3072 sc1
  s_waitcnt vmcnt(13) lgkmcnt(2)
  v_mfma_f32_32x32x16_bf16 v[16:31], a[8:11], v[224:227], v[16:31]
  ds_read_b128 v[216:219], v2 offset:4096
  v_mfma_f32_32x32x16_bf16 v[32:47], a[8:11], v[228:231], v[32:47]
  ds_read_b128 v[220:223], v3 offset:4096
  s_add_u32 s44, s44, 4096
  buffer_load_dwordx4 a[48:51], v1, s[4:7], s44 offen offset:0 sc1
  s_waitcnt vmcnt(13) lgkmcnt(2)
  v_mfma_f32_32x32x16_bf16 v[16:31], a[12:15], v[208:211], v[16:31]
  ds_read_b128 v[224:227], v2 offset:5120
  v_add_u32 v248, s24, v3
  ds_read_b128 v[172:175], v248 offset:0
  v_mfma_f32_32x32x16_bf16 v[32:47], a[12:15], v[212:215], v[32:47]
  ds_read_b128 v[228:231], v3 offset:5120
  buffer_load_dwordx4 a[52:55], v1, s[4:7], s44 offen offset:1024 sc1
  s_waitcnt vmcnt(9) lgkmcnt(3)
  v_mfma_f32_32x32x16_bf16 v[16:31], a[16:19], v[216:219], v[16:31]
  ds_read_b128 v[208:211], v2 offset:6144
  ds_read_b128 v[176:179], v248 offset:1024
  ds_read_b128 v[180:183], v248 offset:2048
  v_mfma_f32_32x32x16_bf16 v[32:47], a[16:19], v[220:223], v[32:47]
  ds_read_b128 v[212:215], v3 offset:6144
  buffer_load_dwordx4 a[56:59], v1, s[4:7], s44 offen offset:2048 sc1
  s_waitcnt vmcnt(9) lgkmcnt(4)
  v_mfma_f32_32x32x16_bf16 v[16:31], a[20:23], v[224:227], v[16:31]
  ds_read_b128 v[216:219], v2 offset:7168
  ds_read_b128 v[184:187], v248 offset:3072
  ds_read_b128 v[188:191], v248 offset:4096
  v_mfma_f32_32x32x16_bf16 v[32:47], a[20:23], v[228:231], v[32:47]
  ds_read_b128 v[220:223], v3 offset:7168
  buffer_load_dwordx4 a[60:63], v1, s[4:7], s44 offen offset:3072 sc1
  s_waitcnt vmcnt(9) lgkmcnt(4)
  v_mfma_f32_32x32x16_bf16 v[16:31], a[24:27], v[208:211], v[16:31]
  ds_read_b128 v[224:227], v2 offset:8192
  ds_read_b128 v[192:195], v248 offset:5120
  ds_read_b128 v[196:199], v248 offset:6144
  v_mfma_f32_32x32x16_bf16 v[32:47], a[24:27], v[212:215], v[32:47]
  ds_read_b128 v[228:231], v3 offset:8192
  s_add_u32 s44, s44, 4096
  buffer_load_dwordx4 a[64:67], v1, s[4:7], s44 offen offset:0 sc1
  s_waitcnt vmcnt(9) lgkmcnt(4)
  v_mfma_f32_32x32x16_bf16 v[16:31], a[28:31], v[216:219], v[16:31]
  ds_read_b128 v[208:211], v2 offset:9216
  ds_read_b128 v[200:203], v248 offset:7168
  v_mfma_f32_32x32x16_bf16 v[32:47], a[28:31], v[220:223], v[32:47]
  ds_read_b128 v[212:215], v3 offset:9216
  buffer_load_dwordx4 a[68:71], v1, s[4:7], s44 offen offset:1024 sc1
  v_add_f32 v132, v116, v118
  s_waitcnt vmcnt(9) lgkmcnt(3)
  v_mfma_f32_32x32x16_bf16 v[16:31], a[32:35], v[224:227], v[16:31]
  ds_read_b128 v[216:219], v2 offset:10240
  v_add_f32 v133, v120, v122
  v_add_f32 v134, v117, v119
  v_add_f32 v135, v121, v123
  v_mfma_f32_32x32x16_bf16 v[32:47], a[32:35], v[228:231], v[32:47]
  ds_read_b128 v[220:223], v3 offset:10240
  buffer_load_dwordx4 a[72:75], v1, s[4:7], s44 offen offset:2048 sc1
  v_add_f32 v132, v132, v124
  s_waitcnt vmcnt(9) lgkmcnt(2)
  v_mfma_f32_32x32x16_bf16 v[16:31], a[36:39], v[208:211], v[16:31]
  ds_read_b128 v[224:227], v2 offset:11264
  v_add_f32 v133, v133, v126
  v_add_f32 v134, v134, v125
  v_add_f32 v135, v135, v127
  v_mfma_f32_32x32x16_bf16 v[32:47], a[36:39], v[212:215], v[32:47]
  ds_read_b128 v[228:231], v3 offset:11264
  buffer_load_dwordx4 a[76:79], v1, s[4:7], s44 offen offset:3072 sc1
  v_add_f32 v132, v132, v128
  s_waitcnt vmcnt(9) lgkmcnt(2)
  v_mfma_f32_32x32x16_bf16 v[16:31], a[40:43], v[216:219], v[16:31]
  ds_read_b128 v[208:211], v2 offset:12288
  v_add_f32 v133, v133, v130
  v_add_f32 v134, v134, v129
  v_add_f32 v135, v135, v131
  v_mfma_f32_32x32x16_bf16 v[32:47], a[40:43], v[220:223], v[32:47]
  ds_read_b128 v[212:215], v3 offset:12288
  s_add_u32 s44, s44, 4096
  buffer_load_dwordx4 a[80:83], v1, s[4:7], s44 offen offset:0 sc1
  v_add_f32 v132, v132, v133
  s_waitcnt vmcnt(9) lgkmcnt(2)
  v_mfma_f32_32x32x16_bf16 v[16:31], a[44:47], v[224:227], v[16:31]
  ds_read_b128 v[216:219], v2 offset:13312
  v_add_f32 v134, v134, v135
  v_mov_b32 v133, v132
  s_nop 1
  v_mfma_f32_32x32x16_bf16 v[32:47], a[44:47], v[228:231], v[32:47]
  ds_read_b128 v[220:223], v3 offset:13312
  buffer_load_dwordx4 a[84:87], v1, s[4:7], s44 offen offset:1024 sc1
  v_permlane32_swap_b32 v132, v133
  s_waitcnt vmcnt(9) lgkmcnt(2)
  v_mfma_f32_32x32x16_bf16 v[16:31], a[48:51], v[208:211], v[16:31]
  ds_read_b128 v[224:227], v2 offset:14336
  v_add_f32 v132, v132, v133
  v_mul_f32 v132, 0x3b000000, v132
  v_mov_b32 v136, 0x3d000000
  v_mfma_f32_32x32x16_bf16 v[32:47], a[48:51], v[212:215], v[32:47]
  ds_read_b128 v[228:231], v3 offset:14336
  buffer_load_dwordx4 a[88:91], v1, s[4:7], s44 offen offset:2048 sc1
  v_fma_f32 v116, v116, v136, -v132
  s_waitcnt vmcnt(9) lgkmcnt(2)
  v_mfma_f32_32x32x16_bf16 v[16:31], a[52:55], v[216:219], v[16:31]
  ds_read_b128 v[208:211], v2 offset:15360
  v_fma_f32 v118, v118, v136, -v132
  v_fma_f32 v120, v120, v136, -v132
  v_fma_f32 v122, v122, v136, -v132
  v_mfma_f32_32x32x16_bf16 v[32:47], a[52:55], v[220:223], v[32:47]
  ds_read_b128 v[212:215], v3 offset:15360
  buffer_load_dwordx4 a[92:95], v1, s[4:7], s44 offen offset:3072 sc1
  v_fma_f32 v124, v124, v136, -v132
  s_waitcnt vmcnt(9) lgkmcnt(2)
  v_mfma_f32_32x32x16_bf16 v[16:31], a[56:59], v[224:227], v[16:31]
  ds_read_b128 v[216:219], v2 offset:16384
  v_fma_f32 v126, v126, v136, -v132
  v_fma_f32 v128, v128, v136, -v132
  v_fma_f32 v130, v130, v136, -v132
  v_mfma_f32_32x32x16_bf16 v[32:47], a[56:59], v[228:231], v[32:47]
  ds_read_b128 v[220:223], v3 offset:16384
  s_add_u32 s44, s44, 4096
  buffer_load_dwordx4 a[96:99], v1, s[4:7], s44 offen offset:0 sc1
  v_mul_f32 v133, v116, v116
  s_waitcnt vmcnt(9) lgkmcnt(2)
  v_mfma_f32_32x32x16_bf16 v[16:31], a[60:63], v[208:211], v[16:31]
  ds_read_b128 v[224:227], v2 offset:17408
  v_mul_f32 v135, v118, v118
  v_fmac_f32 v133, v120, v120
  v_fmac_f32 v135, v122, v122
  v_mfma_f32_32x32x16_bf16 v[32:47], a[60:63], v[212:215], v[32:47]
  ds_read_b128 v[228:231], v3 offset:17408
  buffer_load_dwordx4 a[100:103], v1, s[4:7], s44 offen offset:1024 sc1
  v_fmac_f32 v133, v124, v124
  s_waitcnt vmcnt(9) lgkmcnt(2)
  v_mfma_f32_32x32x16_bf16 v[16:31], a[64:67], v[216:219], v[16:31]
  ds_read_b128 v[208:211], v2 offset:18432
  v_fmac_f32 v135, v126, v126
  v_fmac_f32 v133, v128, v128
  v_fmac_f32 v135, v130, v130
  v_mfma_f32_32x32x16_bf16 v[32:47], a[64:67], v[220:223], v[32:47]
  ds_read_b128 v[212:215], v3 offset:18432
  buffer_load_dwordx4 a[104:107], v1, s[4:7], s44 offen offset:2048 sc1
  v_add_f32 v133, v133, v135
  s_waitcnt vmcnt(9) lgkmcnt(2)
  v_mfma_f32_32x32x16_bf16 v[16:31], a[68:71], v[224:227], v[16:31]
  ds_read_b128 v[216:219], v2 offset:19456
  v_mov_b32 v136, 0x42000000
  v_fmac_f32 v134, v136, v133
  v_mov_b32 v133, v134
  v_mfma_f32_32x32x16_bf16 v[32:47], a[68:71], v[228:231], v[32:47]
  ds_read_b128 v[220:223], v3 offset:19456
  buffer_load_dwordx4 a[108:111], v1, s[4:7], s44 offen offset:3072 sc1
  v_sub_f32 v132, 0, v132
  s_waitcnt vmcnt(9) lgkmcnt(2)
  v_mfma_f32_32x32x16_bf16 v[16:31], a[72:75], v[208:211], v[16:31]
  ds_read_b128 v[224:227], v2 offset:20480
  s_nop 0
  v_permlane32_swap_b32 v134, v133
  v_add_f32 v134, v134, v133
  v_mfma_f32_32x32x16_bf16 v[32:47], a[72:75], v[212:215], v[32:47]
  ds_read_b128 v[228:231], v3 offset:20480
  s_add_u32 s44, s44, 4096
  buffer_load_dwordx4 a[112:115], v1, s[4:7], s44 offen offset:0 sc1
  v_mov_b32 v135, 0x3727c5ac
  s_waitcnt vmcnt(9) lgkmcnt(2)
  v_mfma_f32_32x32x16_bf16 v[16:31], a[76:79], v[216:219], v[16:31]
  ds_read_b128 v[208:211], v2 offset:21504
  v_fmac_f32 v135, 0x3b000000, v134
  v_cvt_pk_bf16_f32 v108, v132, v132
  v_rsq_f32 v104, v135
  v_mfma_f32_32x32x16_bf16 v[32:47], a[76:79], v[220:223], v[32:47]
  ds_read_b128 v[212:215], v3 offset:21504
  buffer_load_dwordx4 a[116:119], v1, s[4:7], s44 offen offset:1024 sc1
  v_lshlrev_b32 v133, 16, v108
  s_waitcnt vmcnt(9) lgkmcnt(2)
  v_mfma_f32_32x32x16_bf16 v[16:31], a[80:83], v[224:227], v[16:31]
  ds_read_b128 v[216:219], v2 offset:22528
  v_sub_f32 v133, v132, v133
  v_mul_f32 v105, 0x3fb8aa3b, v104
  v_mov_b32 v106, v135
  v_mfma_f32_32x32x16_bf16 v[32:47], a[80:83], v[228:231], v[32:47]
  ds_read_b128 v[220:223], v3 offset:22528
  buffer_load_dwordx4 a[120:123], v1, s[4:7], s44 offen offset:2048 sc1
  v_cvt_pk_bf16_f32 v109, v133, v133
  s_waitcnt vmcnt(9) lgkmcnt(2)
  v_mfma_f32_32x32x16_bf16 v[16:31], a[84:87], v[208:211], v[16:31]
  ds_read_b128 v[224:227], v2 offset:23552
  ds_write_b32 v64, v104
  ds_write_b32 v64, v105 offset:128
  v_mfma_f32_32x32x16_bf16 v[32:47], a[84:87], v[212:215], v[32:47]
  ds_read_b128 v[228:231], v3 offset:23552
  buffer_load_dwordx4 a[124:127], v1, s[4:7], s44 offen offset:3072 sc1
  s_waitcnt vmcnt(9) lgkmcnt(4)
  v_mfma_f32_32x32x16_bf16 v[16:31], a[88:91], v[216:219], v[16:31]
  ds_read_b128 v[208:211], v2 offset:24576
  ds_read_b128 v[140:143], v65 offset:0
  ds_read_b128 v[156:159], v65 offset:128
  v_mfma_f32_32x32x16_bf16 v[32:47], a[88:91], v[220:223], v[32:47]
  ds_read_b128 v[212:215], v3 offset:24576
  s_add_u32 s42, s22, s24
  s_add_u32 s43, s25, s24
  s_add_u32 s43, s43, 67584
  s_mov_b32 m0, s42
  s_nop 0
  buffer_load_dwordx4 v1, s[4:7], s43 offen offset:0 lds
  buffer_load_dwordx4 v1, s[4:7], s43 offen offset:1024 lds
  s_waitcnt vmcnt(10) lgkmcnt(4)
  v_mfma_f32_32x32x16_bf16 v[16:31], a[92:95], v[224:227], v[16:31]
  ds_read_b128 v[216:219], v2 offset:25600
  ds_read_b128 v[144:147], v65 offset:32
  ds_read_b128 v[160:163], v65 offset:160
  v_mfma_f32_32x32x16_bf16 v[32:47], a[92:95], v[228:231], v[32:47]
  ds_read_b128 v[220:223], v3 offset:25600
  buffer_load_dwordx4 v1, s[4:7], s43 offen offset:2048 lds
  buffer_load_dwordx4 v1, s[4:7], s43 offen offset:3072 lds
  s_waitcnt vmcnt(11) lgkmcnt(4)
  v_mfma_f32_32x32x16_bf16 v[16:31], a[96:99], v[208:211], v[16:31]
  ds_read_b128 v[224:227], v2 offset:26624
  ds_read_b128 v[148:151], v65 offset:64
  ds_read_b128 v[164:167], v65 offset:192
  v_mfma_f32_32x32x16_bf16 v[32:47], a[96:99], v[212:215], v[32:47]
  ds_read_b128 v[228:231], v3 offset:26624
  s_add_u32 m0, s42, 4096
  s_add_u32 s43, s43, 4096
  buffer_load_dwordx4 v1, s[4:7], s43 offen offset:0 lds
  buffer_load_dwordx4 v1, s[4:7], s43 offen offset:1024 lds
  s_waitcnt vmcnt(12) lgkmcnt(4)
  v_mfma_f32_32x32x16_bf16 v[16:31], a[100:103], v[216:219], v[16:31]
  ds_read_b128 v[208:211], v2 offset:27648
  ds_read_b128 v[152:155], v65 offset:96
  ds_read_b128 v[168:171], v65 offset:224
  v_mfma_f32_32x32x16_bf16 v[32:47], a[100:103], v[220:223], v[32:47]
  ds_read_b128 v[212:215], v3 offset:27648
  buffer_load_dwordx4 v1, s[4:7], s43 offen offset:2048 lds
  buffer_load_dwordx4 v1, s[4:7], s43 offen offset:3072 lds
  s_waitcnt vmcnt(13) lgkmcnt(4)
  v_mfma_f32_32x32x16_bf16 v[16:31], a[104:107], v[224:227], v[16:31]
  ds_read_b128 v[216:219], v2 offset:28672
  v_mov_b32 v134, 0x358637bd
  v_and_b32 v136, 16, v0
  v_mfma_f32_32x32x16_bf16 v[32:47], a[104:107], v[228:231], v[32:47]
  ds_read_b128 v[220:223], v3 offset:28672
  s_add_u32 s42, s23, s24
  s_add_u32 s43, s26, s24
  s_mov_b32 m0, s42
  s_nop 0
  buffer_load_dwordx4 v1, s[4:7], s43 offen offset:0 lds
  buffer_load_dwordx4 v1, s[4:7], s43 offen offset:1024 lds
  s_waitcnt vmcnt(14) lgkmcnt(2)
  v_mfma_f32_32x32x16_bf16 v[16:31], a[108:111], v[208:211], v[16:31]
  ds_read_b128 v[224:227], v2 offset:29696
  v_mfma_f32_32x32x16_bf16 v[32:47], a[108:111], v[212:215], v[32:47]
  ds_read_b128 v[228:231], v3 offset:29696
  buffer_load_dwordx4 v1, s[4:7], s43 offen offset:2048 lds
  buffer_load_dwordx4 v1, s[4:7], s43 offen offset:3072 lds
  s_waitcnt vmcnt(15) lgkmcnt(2)
  v_mfma_f32_32x32x16_bf16 v[16:31], a[112:115], v[216:219], v[16:31]
  ds_read_b128 v[208:211], v2 offset:30720
  v_mfma_f32_32x32x16_bf16 v[32:47], a[112:115], v[220:223], v[32:47]
  ds_read_b128 v[212:215], v3 offset:30720
  s_add_u32 m0, s42, 4096
  s_add_u32 s43, s43, 4096
  buffer_load_dwordx4 v1, s[4:7], s43 offen offset:0 lds
  buffer_load_dwordx4 v1, s[4:7], s43 offen offset:1024 lds
  s_waitcnt vmcnt(16) lgkmcnt(2)
  v_mfma_f32_32x32x16_bf16 v[16:31], a[116:119], v[224:227], v[16:31]
  ds_read_b128 v[216:219], v2 offset:31744
  v_mfma_f32_32x32x16_bf16 v[32:47], a[116:119], v[228:231], v[32:47]
  ds_read_b128 v[220:223], v3 offset:31744
  buffer_load_dwordx4 v1, s[4:7], s43 offen offset:2048 lds
  buffer_load_dwordx4 v1, s[4:7], s43 offen offset:3072 lds
  v_mov_b32 v84, v74
  v_mov_b32 v85, v74
  v_mov_b32 v204, v75
  v_mov_b32 v205, v75
  s_waitcnt vmcnt(17) lgkmcnt(2)
  v_mfma_f32_32x32x16_bf16 v[16:31], a[120:123], v[208:211], v[16:31]
  v_mfma_f32_32x32x16_bf16 v[32:47], a[120:123], v[212:215], v[32:47]
  s_waitcnt vmcnt(16) lgkmcnt(0)
  v_mfma_f32_32x32x16_bf16 v[16:31], a[124:127], v[216:219], v[16:31]
  v_mfma_f32_32x32x16_bf16 v[32:47], a[124:127], v[220:223], v[32:47]
  s_nop 1
  v_mfma_f32_32x32x16_bf16 v[16:31], v[108:111], v[84:87], v[16:31]
  v_mfma_f32_32x32x16_bf16 v[32:47], v[108:111], v[204:207], v[32:47]
  v_cmp_eq_u32 vcc, 0, v136
  s_nop 10
  v_mul_f32 v124, v16, v156
  v_mul_f32 v125, v17, v157
  v_mul_f32 v126, v18, v158
  v_mul_f32 v127, v19, v159
  v_mul_f32 v128, v20, v160
  v_mul_f32 v129, v21, v161
  v_mul_f32 v130, v22, v162
  v_mul_f32 v131, v23, v163
  v_fma_f32 v116, v16, v140, v134
  v_fma_f32 v117, v17, v141, v134
  v_fma_f32 v118, v18, v142, v134
  v_fma_f32 v119, v19, v143, v134
  v_fma_f32 v120, v20, v144, v134
  v_fma_f32 v121, v21, v145, v134
  v_fma_f32 v122, v22, v146, v134
  v_fma_f32 v123, v23, v147, v134
  v_exp_f32 v124, v124 clamp
  v_exp_f32 v125, v125 clamp
  v_exp_f32 v126, v126 clamp
  v_exp_f32 v127, v127 clamp
  v_exp_f32 v128, v128 clamp
  v_exp_f32 v129, v129 clamp
  v_exp_f32 v130, v130 clamp
  v_exp_f32 v131, v131 clamp
  v_max_f32 v116, v116, v134
  v_max_f32 v117, v117, v134
  v_max_f32 v118, v118, v134
  v_max_f32 v119, v119, v134
  v_max_f32 v120, v120, v134
  v_max_f32 v121, v121, v134
  v_max_f32 v122, v122, v134
  v_max_f32 v123, v123, v134
  v_add_f32 v116, v116, v124
  v_add_f32 v117, v117, v125
  v_add_f32 v118, v118, v126
  v_add_f32 v119, v119, v127
  v_add_f32 v120, v120, v128
  v_add_f32 v121, v121, v129
  v_add_f32 v122, v122, v130
  v_add_f32 v123, v123, v131
  v_mul_f32 v124, v32, v140
  v_mul_f32 v125, v33, v141
  v_mul_f32 v126, v34, v142
  v_mul_f32 v127, v35, v143
  v_mul_f32 v128, v36, v144
  v_mul_f32 v129, v37, v145
  v_mul_f32 v130, v38, v146
  v_mul_f32 v131, v39, v147
  v_cvt_pk_bf16_f32 v208, v116, v117
  v_cvt_pk_bf16_f32 v209, v118, v119
  v_cvt_pk_bf16_f32 v210, v120, v121
  v_cvt_pk_bf16_f32 v211, v122, v123
  v_cvt_pk_bf16_f32 v216, v124, v125
  v_cvt_pk_bf16_f32 v217, v126, v127
  v_cvt_pk_bf16_f32 v218, v128, v129
  v_cvt_pk_bf16_f32 v219, v130, v131
  s_nop 1
  v_mfma_f32_32x32x16_bf16 v[48:63], v[208:211], v[216:219], 0
  v_mfma_f32_32x32x16_bf16 v[232:247], v[208:211], v[112:115], 0
  v_mul_f32 v124, v24, v164
  v_mul_f32 v125, v25, v165
  v_mul_f32 v126, v26, v166
  v_mul_f32 v127, v27, v167
  v_mul_f32 v128, v28, v168
  v_mul_f32 v129, v29, v169
  v_mul_f32 v130, v30, v170
  v_mul_f32 v131, v31, v171
  v_fma_f32 v116, v24, v148, v134
  v_fma_f32 v117, v25, v149, v134
  v_fma_f32 v118, v26, v150, v134
  v_fma_f32 v119, v27, v151, v134
  v_fma_f32 v120, v28, v152, v134
  v_fma_f32 v121, v29, v153, v134
  v_fma_f32 v122, v30, v154, v134
  v_fma_f32 v123, v31, v155, v134
  v_exp_f32 v124, v124 clamp
  v_exp_f32 v125, v125 clamp
  v_exp_f32 v126, v126 clamp
  v_exp_f32 v127, v127 clamp
  v_exp_f32 v128, v128 clamp
  v_exp_f32 v129, v129 clamp
  v_exp_f32 v130, v130 clamp
  v_exp_f32 v131, v131 clamp
  v_max_f32 v116, v116, v134
  v_max_f32 v117, v117, v134
  v_max_f32 v118, v118, v134
  v_max_f32 v119, v119, v134
  v_max_f32 v120, v120, v134
  v_max_f32 v121, v121, v134
  v_max_f32 v122, v122, v134
  v_max_f32 v123, v123, v134
  v_add_f32 v116, v116, v124
  v_add_f32 v117, v117, v125
  v_add_f32 v118, v118, v126
  v_add_f32 v119, v119, v127
  v_add_f32 v120, v120, v128
  v_add_f32 v121, v121, v129
  v_add_f32 v122, v122, v130
  v_add_f32 v123, v123, v131
  v_mul_f32 v124, v40, v148
  v_mul_f32 v125, v41, v149
  v_mul_f32 v126, v42, v150
  v_mul_f32 v127, v43, v151
  v_mul_f32 v128, v44, v152
  v_mul_f32 v129, v45, v153
  v_mul_f32 v130, v46, v154
  v_mul_f32 v131, v47, v155
  v_cvt_pk_bf16_f32 v212, v116, v117
  v_cvt_pk_bf16_f32 v213, v118, v119
  v_cvt_pk_bf16_f32 v214, v120, v121
  v_cvt_pk_bf16_f32 v215, v122, v123
  v_cvt_pk_bf16_f32 v220, v124, v125
  v_cvt_pk_bf16_f32 v221, v126, v127
  v_cvt_pk_bf16_f32 v222, v128, v129
  v_cvt_pk_bf16_f32 v223, v130, v131
  s_nop 1
  v_mfma_f32_32x32x16_bf16 v[48:63], v[212:215], v[220:223], v[48:63]
  v_mfma_f32_32x32x16_bf16 v[232:247], v[212:215], v[112:115], v[232:247]
  s_cmp_eq_u32 s12, 2
  s_cselect_b32 s60, 0xff, -1
  s_cselect_b32 s61, 0, -1
  s_mov_b32 s62, 1
  s_mov_b32 s63, 1
  v_add_u32 v133, 136192, v68
  s_add_u32 s49, s38, 8
  v_mov_b32 v10, s49
  v_mov_b32 v11, 0
  s_nop 3
  v_cndmask_b32 v116, v56, v48, vcc
  v_cndmask_b32 v117, v57, v49, vcc
  v_cndmask_b32 v118, v58, v50, vcc
  v_cndmask_b32 v119, v59, v51, vcc
  v_cndmask_b32 v120, v60, v52, vcc
  v_cndmask_b32 v121, v61, v53, vcc
  v_cndmask_b32 v122, v62, v54, vcc
  v_cndmask_b32 v123, v63, v55, vcc
  ds_write_b128 v66, v[116:119]
  ds_write_b128 v66, v[120:123] offset:16
  s_mov_b64 exec, s[62:63]
  ds_write_b128 v67, v[232:235] offset:2048
  ds_write_b128 v67, v[236:239] offset:2064
  ds_write_b128 v67, v[240:243] offset:2112
  ds_write_b128 v67, v[244:247] offset:2128
  s_mov_b64 exec, -1
  s_waitcnt vmcnt(0) lgkmcnt(0)
  s_barrier
  s_cmp_ge_u32 s12, 3
  s_cbranch_scc1 kvp___prompt_8
  s_mov_b64 exec, s[60:61]
  ds_read_b128 v[116:119], v133
  ds_read_b128 v[120:123], v133 offset:2304
  ds_read_b128 v[124:127], v133 offset:4608
  ds_read_b128 v[128:131], v133 offset:6912
  s_waitcnt lgkmcnt(2)
  v_add_f32 v116, v116, v120
  v_add_f32 v117, v117, v121
  v_add_f32 v118, v118, v122
  v_add_f32 v119, v119, v123
  s_waitcnt lgkmcnt(0)
  v_add_f32 v124, v124, v128
  v_add_f32 v125, v125, v129
  v_add_f32 v126, v126, v130
  v_add_f32 v127, v127, v131
  v_add_f32 v116, v116, v124
  v_add_f32 v117, v117, v125
  v_add_f32 v118, v118, v126
  v_add_f32 v119, v119, v127
  buffer_store_dwordx4 v[116:119], v68, s[4:7], s86 offen sc1
  s_mov_b64 exec, -1
kvp___prompt_8:
  ds_read_b128 v[208:211], v4 offset:0
  ds_read_b128 v[212:215], v4 offset:1024
  ds_read_b128 v[216:219], v4 offset:2048
  ds_read_b128 v[220:223], v4 offset:3072
  s_cmp_ge_u32 s12, 3
  s_cbranch_scc1 fa___prompt_9
  s_waitcnt vmcnt(0)
  s_mov_b64 exec, 1
  buffer_store_dword v10, v11, s[4:7], s88 offen sc1
  s_mov_b64 exec, -1
fa___prompt_9:
  ds_read_b128 v[224:227], v4 offset:4096
  s_waitcnt lgkmcnt(3)
  v_mfma_f32_32x32x16_bf16 v[48:63], v[208:211], a[0:3], 0
  s_add_u32 s42, s20, s24
  s_add_u32 s43, s26, s24
  s_add_u32 s43, s43, 32768
  s_mov_b32 m0, s42
  s_nop 0
  buffer_load_dwordx4 v1, s[4:7], s43 offen offset:0 lds
  ds_read_b128 v[228:231], v4 offset:5120
  v_mfma_f32_32x32x16_bf16 v[48:63], v[212:215], a[4:7], v[48:63]
  ds_read_b128 v[208:211], v4 offset:6144
  s_waitcnt lgkmcnt(3)
  v_mfma_f32_32x32x16_bf16 v[48:63], v[216:219], a[8:11], v[48:63]
  buffer_load_dwordx4 v1, s[4:7], s43 offen offset:1024 lds
  ds_read_b128 v[212:215], v4 offset:7168
  v_mfma_f32_32x32x16_bf16 v[48:63], v[220:223], a[12:15], v[48:63]
  ds_read_b128 v[216:219], v4 offset:8192
  s_waitcnt lgkmcnt(3)
  v_mfma_f32_32x32x16_bf16 v[48:63], v[224:227], a[16:19], v[48:63]
  buffer_load_dwordx4 v1, s[4:7], s43 offen offset:2048 lds
  ds_read_b128 v[220:223], v4 offset:9216
  v_mfma_f32_32x32x16_bf16 v[48:63], v[228:231], a[20:23], v[48:63]
  ds_read_b128 v[224:227], v4 offset:10240
  s_waitcnt lgkmcnt(3)
  v_mfma_f32_32x32x16_bf16 v[48:63], v[208:211], a[24:27], v[48:63]
  buffer_load_dwordx4 v1, s[4:7], s43 offen offset:3072 lds
  ds_read_b128 v[228:231], v4 offset:11264
  v_mfma_f32_32x32x16_bf16 v[48:63], v[212:215], a[28:31], v[48:63]
  ds_read_b128 v[208:211], v4 offset:12288
  s_waitcnt lgkmcnt(3)
  v_mfma_f32_32x32x16_bf16 v[48:63], v[216:219], a[32:35], v[48:63]
  s_add_u32 m0, s42, 4096
  s_add_u32 s43, s43, 4096
  buffer_load_dwordx4 v1, s[4:7], s43 offen offset:0 lds
  ds_read_b128 v[212:215], v4 offset:13312
  v_mfma_f32_32x32x16_bf16 v[48:63], v[220:223], a[36:39], v[48:63]
  ds_read_b128 v[216:219], v4 offset:14336
  s_waitcnt lgkmcnt(3)
  v_mfma_f32_32x32x16_bf16 v[48:63], v[224:227], a[40:43], v[48:63]
  buffer_load_dwordx4 v1, s[4:7], s43 offen offset:1024 lds
  ds_read_b128 v[220:223], v4 offset:15360
  v_mfma_f32_32x32x16_bf16 v[48:63], v[228:231], a[44:47], v[48:63]
  ds_read_b128 v[224:227], v4 offset:16384
  s_waitcnt lgkmcnt(3)
  v_mfma_f32_32x32x16_bf16 v[48:63], v[208:211], a[48:51], v[48:63]
  buffer_load_dwordx4 v1, s[4:7], s43 offen offset:2048 lds
  ds_read_b128 v[228:231], v4 offset:17408
  v_mfma_f32_32x32x16_bf16 v[48:63], v[212:215], a[52:55], v[48:63]
  ds_read_b128 v[208:211], v4 offset:18432
  s_waitcnt lgkmcnt(3)
  v_mfma_f32_32x32x16_bf16 v[48:63], v[216:219], a[56:59], v[48:63]
  buffer_load_dwordx4 v1, s[4:7], s43 offen offset:3072 lds
  ds_read_b128 v[212:215], v4 offset:19456
  v_mfma_f32_32x32x16_bf16 v[48:63], v[220:223], a[60:63], v[48:63]
  ds_read_b128 v[216:219], v4 offset:20480
  s_waitcnt lgkmcnt(3)
  v_mfma_f32_32x32x16_bf16 v[48:63], v[224:227], a[64:67], v[48:63]
  s_add_u32 s42, s21, s24
  s_add_u32 s43, s27, s24
  s_mov_b32 m0, s42
  s_nop 0
  buffer_load_dwordx4 v1, s[4:7], s43 offen offset:0 lds
  ds_read_b128 v[220:223], v4 offset:21504
  v_mfma_f32_32x32x16_bf16 v[48:63], v[228:231], a[68:71], v[48:63]
  ds_read_b128 v[224:227], v4 offset:22528
  s_waitcnt lgkmcnt(3)
  v_mfma_f32_32x32x16_bf16 v[48:63], v[208:211], a[72:75], v[48:63]
  buffer_load_dwordx4 v1, s[4:7], s43 offen offset:1024 lds
  ds_read_b128 v[228:231], v4 offset:23552
  v_mfma_f32_32x32x16_bf16 v[48:63], v[212:215], a[76:79], v[48:63]
  ds_read_b128 v[208:211], v4 offset:24576
  s_waitcnt lgkmcnt(3)
  v_mfma_f32_32x32x16_bf16 v[48:63], v[216:219], a[80:83], v[48:63]
  buffer_load_dwordx4 v1, s[4:7], s43 offen offset:2048 lds
  ds_read_b128 v[212:215], v4 offset:25600
  v_mfma_f32_32x32x16_bf16 v[48:63], v[220:223], a[84:87], v[48:63]
  ds_read_b128 v[216:219], v4 offset:26624
  s_waitcnt lgkmcnt(3)
  v_mfma_f32_32x32x16_bf16 v[48:63], v[224:227], a[88:91], v[48:63]
  buffer_load_dwordx4 v1, s[4:7], s43 offen offset:3072 lds
  ds_read_b128 v[220:223], v4 offset:27648
  v_mfma_f32_32x32x16_bf16 v[48:63], v[228:231], a[92:95], v[48:63]
  ds_read_b128 v[224:227], v4 offset:28672
  s_waitcnt lgkmcnt(3)
  v_mfma_f32_32x32x16_bf16 v[48:63], v[208:211], a[96:99], v[48:63]
  s_add_u32 m0, s42, 4096
  s_add_u32 s43, s43, 4096
  buffer_load_dwordx4 v1, s[4:7], s43 offen offset:0 lds
  ds_read_b128 v[228:231], v4 offset:29696
  v_mfma_f32_32x32x16_bf16 v[48:63], v[212:215], a[100:103], v[48:63]
  ds_read_b128 v[208:211], v4 offset:30720
  s_waitcnt lgkmcnt(3)
  v_mfma_f32_32x32x16_bf16 v[48:63], v[216:219], a[104:107], v[48:63]
  buffer_load_dwordx4 v1, s[4:7], s43 offen offset:1024 lds
  ds_read_b128 v[212:215], v4 offset:31744
  v_mfma_f32_32x32x16_bf16 v[48:63], v[220:223], a[108:111], v[48:63]
  v_mov_b32 v84, v76
  v_mov_b32 v85, v76
  s_waitcnt lgkmcnt(2)
  v_mfma_f32_32x32x16_bf16 v[48:63], v[224:227], a[112:115], v[48:63]
  buffer_load_dwordx4 v1, s[4:7], s43 offen offset:2048 lds
  v_mfma_f32_32x32x16_bf16 v[48:63], v[228:231], a[116:119], v[48:63]
  s_waitcnt lgkmcnt(0)
  v_mfma_f32_32x32x16_bf16 v[48:63], v[208:211], a[120:123], v[48:63]
  buffer_load_dwordx4 v1, s[4:7], s43 offen offset:3072 lds
  v_mfma_f32_32x32x16_bf16 v[48:63], v[212:215], a[124:127], v[48:63]
  v_mfma_f32_32x32x16_bf16 v[48:63], v[84:87], v[108:111], v[48:63]
  s_mov_b32 s62, 0x77777777
  s_mov_b32 s63, 0x77777777
  s_cmp_ge_u32 s12, 3
  s_cbranch_scc1 gat___prompt_10
  s_cmp_lg_u32 s12, 0
  s_cbranch_scc1 regchk___prompt_11
  s_cmp_lg_u32 s15, 99
  s_cbranch_scc1 regchk___prompt_11
  s_lshl_b32 s45, s13, 7
  s_add_u32 s45, s45, 4096
  s_add_u32 s47, s38, 1
  s_mov_b32 s46, 0
poll___prompt_12:
  s_add_u32 s46, s46, 1
  s_cmp_gt_u32 s46, 4194304
  s_cbranch_scc1 pollt___prompt_14
  buffer_load_dword v9, v8, s[4:7], s45 offen sc1
  s_waitcnt vmcnt(0)
  v_subrev_u32 v10, s47, v9
  v_cmp_le_u32 vcc, 8, v10
  s_cbranch_vccz pollx___prompt_13
  s_branch poll___prompt_12
pollt___prompt_14:
  s_mov_b32 s18, 2
pollx___prompt_13:
  v_cmp_ne_u32 vcc, s19, v9
  s_cmp_lg_u64 vcc, 0
  s_cselect_b32 s47, 1, 0
  v_mov_b32 v10, s47
  v_mov_b32 v11, 147648
  ds_write_b32 v11, v10
  s_waitcnt lgkmcnt(0)
regchk___prompt_11:
  s_mov_b32 s46, 0
gp___prompt_15:
  s_add_u32 s46, s46, 1
  s_cmp_gt_u32 s46, 4194304
  s_cbranch_scc1 gpt___prompt_17
  buffer_load_dword v9, v73, s[4:7], s89 offen sc1
  s_waitcnt vmcnt(0)
  v_cmp_ne_u32 vcc, s49, v9
  s_nop 1
  s_and_b64 vcc, vcc, s[62:63]
  s_cbranch_scc1 gp___prompt_15
  s_branch gpx___prompt_16
gpt___prompt_17:
  s_mov_b32 s18, 3
gpx___prompt_16:
  s_mov_b64 exec, s[60:61]
  s_mov_b32 s45, s87
  buffer_load_dwordx4 v[140:143], v68, s[4:7], s45 offen sc1
  s_add_u32 s45, s45, 2304
  buffer_load_dwordx4 v[144:147], v68, s[4:7], s45 offen sc1
  s_add_u32 s45, s45, 2304
  buffer_load_dwordx4 v[148:151], v68, s[4:7], s45 offen sc1
  s_add_u32 s45, s45, 2304
  buffer_load_dwordx4 v[152:155], v68, s[4:7], s45 offen sc1
  s_add_u32 s45, s45, 2304
  buffer_load_dwordx4 v[156:159], v68, s[4:7], s45 offen sc1
  s_add_u32 s45, s45, 2304
  buffer_load_dwordx4 v[160:163], v68, s[4:7], s45 offen sc1
  s_add_u32 s45, s45, 2304
  buffer_load_dwordx4 v[164:167], v68, s[4:7], s45 offen sc1
  s_add_u32 s45, s45, 2304
  buffer_load_dwordx4 v[168:171], v68, s[4:7], s45 offen sc1
  s_add_u32 s45, s45, 2304
  buffer_load_dwordx4 v[208:211], v68, s[4:7], s45 offen sc1
  s_add_u32 s45, s45, 2304
  buffer_load_dwordx4 v[212:215], v68, s[4:7], s45 offen sc1
  s_add_u32 s45, s45, 2304
  buffer_load_dwordx4 v[216:219], v68, s[4:7], s45 offen sc1
  s_add_u32 s45, s45, 2304
  buffer_load_dwordx4 v[220:223], v68, s[4:7], s45 offen sc1
  s_add_u32 s45, s45, 2304
  buffer_load_dwordx4 v[224:227], v68, s[4:7], s45 offen sc1
  s_add_u32 s45, s45, 2304
  buffer_load_dwordx4 v[228:231], v68, s[4:7], s45 offen sc1
  s_add_u32 s45, s45, 2304
  buffer_load_dwordx4 v[232:235], v68, s[4:7], s45 offen sc1
  s_add_u32 s45, s45, 2304
  buffer_load_dwordx4 v[236:239], v68, s[4:7], s45 offen sc1
  s_mov_b64 exec, -1
gat___prompt_10:
  v_mov_b32 v12, 0x358637bd
  s_nop 7
  v_mul_f32 v124, v48, v105
  v_mul_f32 v125, v49, v105
  v_mul_f32 v126, v50, v105
  v_mul_f32 v127, v51, v105
  v_mul_f32 v128, v52, v105
  v_mul_f32 v129, v53, v105
  v_mul_f32 v130, v54, v105
  v_mul_f32 v131, v55, v105
  v_fma_f32 v116, v48, v104, v12
  v_fma_f32 v117, v49, v104, v12
  v_fma_f32 v118, v50, v104, v12
  v_fma_f32 v119, v51, v104, v12
  v_fma_f32 v120, v52, v104, v12
  v_fma_f32 v121, v53, v104, v12
  v_fma_f32 v122, v54, v104, v12
  v_fma_f32 v123, v55, v104, v12
  v_exp_f32 v124, v124 clamp
  v_exp_f32 v125, v125 clamp
  v_exp_f32 v126, v126 clamp
  v_exp_f32 v127, v127 clamp
  v_exp_f32 v128, v128 clamp
  v_exp_f32 v129, v129 clamp
  v_exp_f32 v130, v130 clamp
  v_exp_f32 v131, v131 clamp
  v_max_f32 v116, v116, v12
  v_max_f32 v117, v117, v12
  v_max_f32 v118, v118, v12
  v_max_f32 v119, v119, v12
  v_max_f32 v120, v120, v12
  v_max_f32 v121, v121, v12
  v_max_f32 v122, v122, v12
  v_max_f32 v123, v123, v12
  v_add_f32 v116, v116, v124
  v_add_f32 v117, v117, v125
  v_add_f32 v118, v118, v126
  v_add_f32 v119, v119, v127
  v_add_f32 v120, v120, v128
  v_add_f32 v121, v121, v129
  v_add_f32 v122, v122, v130
  v_add_f32 v123, v123, v131
  v_cvt_pk_bf16_f32 v96, v116, v117
  v_cvt_pk_bf16_f32 v97, v118, v119
  v_cvt_pk_bf16_f32 v98, v120, v121
  v_cvt_pk_bf16_f32 v99, v122, v123
  v_mul_f32 v124, v56, v105
  v_mul_f32 v125, v57, v105
  v_mul_f32 v126, v58, v105
  v_mul_f32 v127, v59, v105
  v_mul_f32 v128, v60, v105
  v_mul_f32 v129, v61, v105
  v_mul_f32 v130, v62, v105
  v_mul_f32 v131, v63, v105
  v_fma_f32 v116, v56, v104, v12
  v_fma_f32 v117, v57, v104, v12
  v_fma_f32 v118, v58, v104, v12
  v_fma_f32 v119, v59, v104, v12
  v_fma_f32 v120, v60, v104, v12
  v_fma_f32 v121, v61, v104, v12
  v_fma_f32 v122, v62, v104, v12
  v_fma_f32 v123, v63, v104, v12
  v_exp_f32 v124, v124 clamp
  v_exp_f32 v125, v125 clamp
  v_exp_f32 v126, v126 clamp
  v_exp_f32 v127, v127 clamp
  v_exp_f32 v128, v128 clamp
  v_exp_f32 v129, v129 clamp
  v_exp_f32 v130, v130 clamp
  v_exp_f32 v131, v131 clamp
  v_max_f32 v116, v116, v12
  v_max_f32 v117, v117, v12
  v_max_f32 v118, v118, v12
  v_max_f32 v119, v119, v12
  v_max_f32 v120, v120, v12
  v_max_f32 v121, v121, v12
  v_max_f32 v122, v122, v12
  v_max_f32 v123, v123, v12
  v_add_f32 v116, v116, v124
  v_add_f32 v117, v117, v125
  v_add_f32 v118, v118, v126
  v_add_f32 v119, v119, v127
  v_add_f32 v120, v120, v128
  v_add_f32 v121, v121, v129
  v_add_f32 v122, v122, v130
  v_add_f32 v123, v123, v131
  v_cvt_pk_bf16_f32 v100, v116, v117
  v_cvt_pk_bf16_f32 v101, v118, v119
  v_cvt_pk_bf16_f32 v102, v120, v121
  v_cvt_pk_bf16_f32 v103, v122, v123
  s_cmp_ge_u32 s12, 3
  s_cbranch_scc1 gat2___prompt_18
  s_mov_b64 exec, s[60:61]
  v_add_u32 v133, 145408, v68
  s_waitcnt vmcnt(8)
  v_add_f32 v140, v140, v144
  v_add_f32 v141, v141, v145
  v_add_f32 v142, v142, v146
  v_add_f32 v143, v143, v147
  v_add_f32 v148, v148, v152
  v_add_f32 v149, v149, v153
  v_add_f32 v150, v150, v154
  v_add_f32 v151, v151, v155
  v_add_f32 v156, v156, v160
  v_add_f32 v157, v157, v161
  v_add_f32 v158, v158, v162
  v_add_f32 v159, v159, v163
  v_add_f32 v164, v164, v168
  v_add_f32 v165, v165, v169
  v_add_f32 v166, v166, v170
  v_add_f32 v167, v167, v171
  v_add_f32 v140, v140, v148
  v_add_f32 v141, v141, v149
  v_add_f32 v142, v142, v150
  v_add_f32 v143, v143, v151
  v_add_f32 v156, v156, v164
  v_add_f32 v157, v157, v165
  v_add_f32 v158, v158, v166
  v_add_f32 v159, v159, v167
  v_add_f32 v140, v140, v156
  v_add_f32 v141, v141, v157
  v_add_f32 v142, v142, v158
  v_add_f32 v143, v143, v159
  s_waitcnt vmcnt(0)
  v_add_f32 v208, v208, v212
  v_add_f32 v209, v209, v213
  v_add_f32 v210, v210, v214
  v_add_f32 v211, v211, v215
  v_add_f32 v216, v216, v220
  v_add_f32 v217, v217, v221
  v_add_f32 v218, v218, v222
  v_add_f32 v219, v219, v223
  v_add_f32 v224, v224, v228
  v_add_f32 v225, v225, v229
  v_add_f32 v226, v226, v230
  v_add_f32 v227, v227, v231
  v_add_f32 v232, v232, v236
  v_add_f32 v233, v233, v237
  v_add_f32 v234, v234, v238
  v_add_f32 v235, v235, v239
  v_add_f32 v208, v208, v216
  v_add_f32 v209, v209, v217
  v_add_f32 v210, v210, v218
  v_add_f32 v211, v211, v219
  v_add_f32 v224, v224, v232
  v_add_f32 v225, v225, v233
  v_add_f32 v226, v226, v234
  v_add_f32 v227, v227, v235
  v_add_f32 v208, v208, v224
  v_add_f32 v209, v209, v225
  v_add_f32 v210, v210, v226
  v_add_f32 v211, v211, v227
  v_add_f32 v140, v140, v208
  v_add_f32 v141, v141, v209
  v_add_f32 v142, v142, v210
  v_add_f32 v143, v143, v211
  ds_write_b128 v133, v[140:143]
  s_mov_b64 exec, -1
gat2___prompt_18:
  s_waitcnt vmcnt(0) lgkmcnt(0)
  s_barrier
  ds_read_b128 v[116:119], v69
  ds_read_b128 v[120:123], v69 offset:16
  ds_read_b128 v[124:127], v70
  ds_read_b128 v[128:131], v70 offset:16
  s_cmp_lg_u32 s15, 99
  s_cbranch_scc1 mode___prompt_19
  v_mov_b32 v11, 147648
  ds_read_b32 v10, v11
  s_waitcnt lgkmcnt(0)
  v_readfirstlane_b32 s16, v10
mode___prompt_19:
  s_waitcnt lgkmcnt(2)
  v_cvt_pk_bf16_f32 v208, v116, v117
  v_cvt_pk_bf16_f32 v209, v118, v119
  v_cvt_pk_bf16_f32 v210, v120, v121
  v_cvt_pk_bf16_f32 v211, v122, v123
  s_waitcnt lgkmcnt(0)
  v_cvt_pk_bf16_f32 v212, v124, v125
  v_cvt_pk_bf16_f32 v213, v126, v127
  v_cvt_pk_bf16_f32 v214, v128, v129
  v_cvt_pk_bf16_f32 v215, v130, v131
  s_nop 0
  v_mfma_f32_32x32x16_bf16 v[16:31], v[208:211], v[96:99], 0
  v_mfma_f32_32x32x16_bf16 v[32:47], v[212:215], v[100:103], 0
  s_nop 10
  v_add_f32 v132, v24, v12
  v_add_f32 v133, v40, v12
  v_rcp_f32 v132, v132
  v_rcp_f32 v133, v133
  s_nop 0
  v_mul_f32 v116, v16, v132
  v_mul_f32 v117, v17, v132
  v_mul_f32 v118, v18, v132
  v_mul_f32 v119, v19, v132
  v_mul_f32 v120, v20, v132
  v_mul_f32 v121, v21, v132
  v_mul_f32 v122, v22, v132
  v_mul_f32 v123, v23, v132
  v_cvt_pk_bf16_f32 v216, v116, v117
  v_cvt_pk_bf16_f32 v217, v118, v119
  v_cvt_pk_bf16_f32 v218, v120, v121
  v_cvt_pk_bf16_f32 v219, v122, v123
  buffer_store_dwordx4 v[216:219], v1, s[4:7], s84 offen offset:0 sc1
  v_mul_f32 v124, v32, v133
  v_mul_f32 v125, v33, v133
  v_mul_f32 v126, v34, v133
  v_mul_f32 v127, v35, v133
  v_mul_f32 v128, v36, v133
  v_mul_f32 v129, v37, v133
  v_mul_f32 v130, v38, v133
  v_mul_f32 v131, v39, v133
  v_cvt_pk_bf16_f32 v220, v124, v125
  v_cvt_pk_bf16_f32 v221, v126, v127
  v_cvt_pk_bf16_f32 v222, v128, v129
  v_cvt_pk_bf16_f32 v223, v130, v131
  buffer_store_dwordx4 v[220:223], v1, s[4:7], s84 offen offset:1024 sc1
  s_waitcnt vmcnt(0)
  s_barrier
  s_add_u32 s17, s17, 1
  s_cmp_lg_u32 s12, 0
  s_cbranch_scc1 hop___prompt_20
  s_lshl_b32 s45, s14, 2
  s_add_u32 s45, s45, s37
  v_mov_b32 v10, s17
  v_mov_b32 v11, 0
  s_mov_b64 exec, 1
  s_cmp_lg_u32 s16, 0
  s_cbranch_scc1 fs___prompt_21
  buffer_store_dword v10, v11, s[4:7], s45 offen
  s_branch fd___prompt_22
fs___prompt_21:
  buffer_store_dword v10, v11, s[4:7], s45 offen sc1
fd___prompt_22:
  s_mov_b64 exec, -1
  s_mov_b32 s46, 0
poll___prompt_23:
  s_add_u32 s46, s46, 1
  s_cmp_gt_u32 s46, 4194304
  s_cbranch_scc1 pollt___prompt_25
  buffer_load_dword v9, v8, s[4:7], s37 offen sc1
  s_waitcnt vmcnt(0)
  v_subrev_u32 v10, s17, v9
  v_cmp_le_u32 vcc, 8, v10
  s_cbranch_vccz pollx___prompt_24
  s_branch poll___prompt_23
pollt___prompt_25:
  s_mov_b32 s18, 1
pollx___prompt_24:
hop___prompt_20:
  s_barrier
  s_lshl_b32 s44, s13, 2
  s_add_u32 s44, s44, s36
  s_mul_i32 s44, s44, 32768
  s_mul_i32 s45, s33, 16384
  s_add_u32 s44, s44, s45
  s_add_u32 s44, s44, 16777216
  v_add_u32 v132, s53, v5
  v_add_u32 v133, s54, v5
  buffer_load_dwordx4 a[0:3], v1, s[4:7], s44 offen offset:0 sc1
  buffer_load_dwordx4 a[4:7], v1, s[4:7], s44 offen offset:1024 sc1
  ds_read_b128 v[208:211], v132 offset:0
  ds_read_b128 v[212:215], v133 offset:0
  ds_read_b128 v[216:219], v132 offset:4096
  ds_read_b128 v[220:223], v133 offset:4096
  buffer_load_dwordx4 a[8:11], v1, s[4:7], s44 offen offset:2048 sc1
  buffer_load_dwordx4 a[12:15], v1, s[4:7], s44 offen offset:3072 sc1
  s_add_u32 s44, s44, 4096
  buffer_load_dwordx4 a[16:19], v1, s[4:7], s44 offen offset:0 sc1
  buffer_load_dwordx4 a[20:23], v1, s[4:7], s44 offen offset:1024 sc1
  buffer_load_dwordx4 a[24:27], v1, s[4:7], s44 offen offset:2048 sc1
  buffer_load_dwordx4 a[28:31], v1, s[4:7], s44 offen offset:3072 sc1
  s_add_u32 s44, s44, 4096
  buffer_load_dwordx4 a[32:35], v1, s[4:7], s44 offen offset:0 sc1
  buffer_load_dwordx4 a[36:39], v1, s[4:7], s44 offen offset:1024 sc1
  v_add_u32 v134, s53, v2
  v_add_u32 v135, s54, v2
  s_waitcnt vmcnt(9) lgkmcnt(2)
  v_mfma_f32_32x32x16_bf16 v[16:31], v[208:211], a[0:3], 0
  ds_read_b128 v[224:227], v132 offset:8192
  v_mfma_f32_32x32x16_bf16 v[32:47], v[212:215], a[0:3], 0
  ds_read_b128 v[228:231], v133 offset:8192
  buffer_load_dwordx4 a[40:43], v1, s[4:7], s44 offen offset:2048 sc1
  s_waitcnt vmcnt(9) lgkmcnt(2)
  v_mfma_f32_32x32x16_bf16 v[16:31], v[216:219], a[4:7], v[16:31]
  ds_read_b128 v[208:211], v132 offset:12288
  v_mfma_f32_32x32x16_bf16 v[32:47], v[220:223], a[4:7], v[32:47]
  ds_read_b128 v[212:215], v133 offset:12288
  buffer_load_dwordx4 a[44:47], v1, s[4:7], s44 offen offset:3072 sc1
  s_waitcnt vmcnt(9) lgkmcnt(2)
  v_mfma_f32_32x32x16_bf16 v[16:31], v[224:227], a[8:11], v[16:31]
  ds_read_b128 v[216:219], v132 offset:16384
  v_mfma_f32_32x32x16_bf16 v[32:47], v[228:231], a[8:11], v[32:47]
  ds_read_b128 v[220:223], v133 offset:16384
  s_add_u32 s44, s44, 4096
  buffer_load_dwordx4 a[48:51], v1, s[4:7], s44 offen offset:0 sc1
  s_waitcnt vmcnt(9) lgkmcnt(2)
  v_mfma_f32_32x32x16_bf16 v[16:31], v[208:211], a[12:15], v[16:31]
  ds_read_b128 v[224:227], v132 offset:20480
  v_mfma_f32_32x32x16_bf16 v[32:47], v[212:215], a[12:15], v[32:47]
  ds_read_b128 v[228:231], v133 offset:20480
  buffer_load_dwordx4 a[52:55], v1, s[4:7], s44 offen offset:1024 sc1
  s_waitcnt vmcnt(9) lgkmcnt(2)
  v_mfma_f32_32x32x16_bf16 v[16:31], v[216:219], a[16:19], v[16:31]
  ds_read_b128 v[208:211], v132 offset:24576
  v_mfma_f32_32x32x16_bf16 v[32:47], v[220:223], a[16:19], v[32:47]
  ds_read_b128 v[212:215], v133 offset:24576
  buffer_load_dwordx4 a[56:59], v1, s[4:7], s44 offen offset:2048 sc1
  s_waitcnt vmcnt(9) lgkmcnt(2)
  v_mfma_f32_32x32x16_bf16 v[16:31], v[224:227], a[20:23], v[16:31]
  ds_read_b128 v[216:219], v132 offset:28672
  v_mfma_f32_32x32x16_bf16 v[32:47], v[228:231], a[20:23], v[32:47]
  ds_read_b128 v[220:223], v133 offset:28672
  buffer_load_dwordx4 a[60:63], v1, s[4:7], s44 offen offset:3072 sc1
  s_add_u32 s42, s22, s24
  s_add_u32 s43, s27, s24
  s_add_u32 s43, s43, 33792
  s_mov_b32 m0, s42
  s_nop 0
  buffer_load_dwordx4 v1, s[4:7], s43 offen offset:0 lds
  buffer_load_dwordx4 v1, s[4:7], s43 offen offset:1024 lds
  s_barrier
  s_waitcnt vmcnt(11) lgkmcnt(2)
  v_mfma_f32_32x32x16_bf16 v[16:31], v[208:211], a[24:27], v[16:31]
  ds_read_b128 v[224:227], v134 offset:0
  v_mfma_f32_32x32x16_bf16 v[32:47], v[212:215], a[24:27], v[32:47]
  ds_read_b128 v[228:231], v135 offset:0
  buffer_load_dwordx4 v1, s[4:7], s43 offen offset:2048 lds
  buffer_load_dwordx4 v1, s[4:7], s43 offen offset:3072 lds
  s_waitcnt vmcnt(12) lgkmcnt(2)
  v_mfma_f32_32x32x16_bf16 v[16:31], v[216:219], a[28:31], v[16:31]
  ds_read_b128 v[208:211], v134 offset:4096
  v_mfma_f32_32x32x16_bf16 v[32:47], v[220:223], a[28:31], v[32:47]
  ds_read_b128 v[212:215], v135 offset:4096
  s_add_u32 m0, s42, 4096
  s_add_u32 s43, s43, 4096
  buffer_load_dwordx4 v1, s[4:7], s43 offen offset:0 lds
  buffer_load_dwordx4 v1, s[4:7], s43 offen offset:1024 lds
  s_waitcnt vmcnt(13) lgkmcnt(2)
  v_mfma_f32_32x32x16_bf16 v[16:31], v[224:227], a[32:35], v[16:31]
  ds_read_b128 v[216:219], v134 offset:8192
  v_mfma_f32_32x32x16_bf16 v[32:47], v[228:231], a[32:35], v[32:47]
  ds_read_b128 v[220:223], v135 offset:8192
  buffer_load_dwordx4 v1, s[4:7], s43 offen offset:2048 lds
  buffer_load_dwordx4 v1, s[4:7], s43 offen offset:3072 lds
  s_waitcnt vmcnt(14) lgkmcnt(2)
  v_mfma_f32_32x32x16_bf16 v[16:31], v[208:211], a[36:39], v[16:31]
  ds_read_b128 v[224:227], v134 offset:12288
  v_mfma_f32_32x32x16_bf16 v[32:47], v[212:215], a[36:39], v[32:47]
  ds_read_b128 v[228:231], v135 offset:12288
  s_waitcnt vmcnt(13) lgkmcnt(2)
  v_mfma_f32_32x32x16_bf16 v[16:31], v[216:219], a[40:43], v[16:31]
  ds_read_b128 v[208:211], v134 offset:16384
  v_mfma_f32_32x32x16_bf16 v[32:47], v[220:223], a[40:43], v[32:47]
  ds_read_b128 v[212:215], v135 offset:16384
  s_waitcnt vmcnt(12) lgkmcnt(2)
  v_mfma_f32_32x32x16_bf16 v[16:31], v[224:227], a[44:47], v[16:31]
  ds_read_b128 v[216:219], v134 offset:20480
  v_mfma_f32_32x32x16_bf16 v[32:47], v[228:231], a[44:47], v[32:47]
  ds_read_b128 v[220:223], v135 offset:20480
  s_waitcnt vmcnt(11) lgkmcnt(2)
  v_mfma_f32_32x32x16_bf16 v[16:31], v[208:211], a[48:51], v[16:31]
  ds_read_b128 v[224:227], v134 offset:24576
  v_mfma_f32_32x32x16_bf16 v[32:47], v[212:215], a[48:51], v[32:47]
  ds_read_b128 v[228:231], v135 offset:24576
  s_waitcnt vmcnt(10) lgkmcnt(2)
  v_mfma_f32_32x32x16_bf16 v[16:31], v[216:219], a[52:55], v[16:31]
  ds_read_b128 v[208:211], v134 offset:28672
  v_mfma_f32_32x32x16_bf16 v[32:47], v[220:223], a[52:55], v[32:47]
  ds_read_b128 v[212:215], v135 offset:28672
  s_barrier
  s_waitcnt vmcnt(9) lgkmcnt(2)
  v_mfma_f32_32x32x16_bf16 v[16:31], v[224:227], a[56:59], v[16:31]
  v_mfma_f32_32x32x16_bf16 v[32:47], v[228:231], a[56:59], v[32:47]
  s_waitcnt vmcnt(8) lgkmcnt(0)
  v_mfma_f32_32x32x16_bf16 v[16:31], v[208:211], a[60:63], v[16:31]
  v_mfma_f32_32x32x16_bf16 v[32:47], v[212:215], a[60:63], v[32:47]
  s_add_u32 s42, s23, s24
  s_add_u32 s43, s27, s24
  s_add_u32 s43, s43, 67584
  s_mov_b32 m0, s42
  s_nop 0
  buffer_load_dwordx4 v1, s[4:7], s43 offen offset:0 lds
  buffer_load_dwordx4 v1, s[4:7], s43 offen offset:1024 lds
  buffer_load_dwordx4 v1, s[4:7], s43 offen offset:2048 lds
  buffer_load_dwordx4 v1, s[4:7], s43 offen offset:3072 lds
  v_lshlrev_b32 v140, 16, v88
  v_and_b32 v141, 0xffff0000, v88
  v_lshlrev_b32 v142, 16, v89
  v_and_b32 v143, 0xffff0000, v89
  v_lshlrev_b32 v144, 16, v90
  v_and_b32 v145, 0xffff0000, v90
  v_lshlrev_b32 v146, 16, v91
  v_and_b32 v147, 0xffff0000, v91
  v_lshlrev_b32 v148, 16, v92
  v_and_b32 v149, 0xffff0000, v92
  v_lshlrev_b32 v150, 16, v93
  v_and_b32 v151, 0xffff0000, v93
  ds_write_b128 v71, v[32:35] offset:0
  ds_write_b128 v71, v[36:39] offset:1024
  ds_write_b128 v71, v[40:43] offset:2048
  ds_write_b128 v71, v[44:47] offset:3072
  v_lshlrev_b32 v152, 16, v94
  v_and_b32 v153, 0xffff0000, v94
  v_lshlrev_b32 v154, 16, v95
  v_and_b32 v155, 0xffff0000, v95
  v_add_f32 v140, v140, v16
  v_add_f32 v141, v141, v17
  v_add_f32 v142, v142, v18
  v_add_f32 v143, v143, v19
  v_add_f32 v144, v144, v20
  v_add_f32 v145, v145, v21
  v_add_f32 v146, v146, v22
  v_add_f32 v147, v147, v23
  v_add_f32 v148, v148, v24
  v_add_f32 v149, v149, v25
  v_add_f32 v150, v150, v26
  v_add_f32 v151, v151, v27
  v_add_f32 v152, v152, v28
  v_add_f32 v153, v153, v29
  v_add_f32 v154, v154, v30
  v_add_f32 v155, v155, v31
  s_waitcnt lgkmcnt(0)
  s_barrier
  ds_read_b128 v[48:51], v72 offset:0
  ds_read_b128 v[52:55], v72 offset:1024
  ds_read_b128 v[56:59], v72 offset:2048
  ds_read_b128 v[60:63], v72 offset:3072
  s_waitcnt lgkmcnt(3)
  v_add_f32 v140, v140, v48
  v_add_f32 v141, v141, v49
  v_add_f32 v142, v142, v50
  v_add_f32 v143, v143, v51
  s_add_u32 m0, s42, 4096
  s_add_u32 s43, s43, 4096
  buffer_load_dwordx4 v1, s[4:7], s43 offen offset:0 lds
  v_cvt_pk_bf16_f32 v88, v140, v141
  v_cvt_pk_bf16_f32 v89, v142, v143
  s_waitcnt lgkmcnt(2)
  v_add_f32 v144, v144, v52
  v_add_f32 v145, v145, v53
  buffer_load_dwordx4 v1, s[4:7], s43 offen offset:1024 lds
  v_add_f32 v146, v146, v54
  v_add_f32 v147, v147, v55
  v_cvt_pk_bf16_f32 v90, v144, v145
  v_cvt_pk_bf16_f32 v91, v146, v147
  buffer_load_dwordx4 v1, s[4:7], s43 offen offset:2048 lds
  s_waitcnt lgkmcnt(1)
  v_add_f32 v148, v148, v56
  v_add_f32 v149, v149, v57
  v_add_f32 v150, v150, v58
  v_add_f32 v151, v151, v59
  buffer_load_dwordx4 v1, s[4:7], s43 offen offset:3072 lds
  v_cvt_pk_bf16_f32 v92, v148, v149
  v_cvt_pk_bf16_f32 v93, v150, v151
  s_waitcnt lgkmcnt(0)
  v_add_f32 v152, v152, v60
  v_add_f32 v153, v153, v61
  v_add_f32 v154, v154, v62
  v_add_f32 v155, v155, v63
  v_cvt_pk_bf16_f32 v94, v152, v153
  v_cvt_pk_bf16_f32 v95, v154, v155
  s_cmp_lg_u32 s16, 0
  s_cbranch_scc1 st___prompt_28
  buffer_store_dwordx4 v[88:91], v1, s[4:7], s82 offen
  buffer_store_dwordx4 v[92:95], v1, s[4:7], s82 offen offset:1024
  s_branch sd___prompt_29
st___prompt_28:
  buffer_store_dwordx4 v[88:91], v1, s[4:7], s82 offen sc1
  buffer_store_dwordx4 v[92:95], v1, s[4:7], s82 offen offset:1024 sc1
sd___prompt_29:
  v_add_f32 v138, v140, v144
  v_add_f32 v134, v141, v145
  v_add_f32 v135, v142, v146
  v_add_f32 v136, v143, v147
  v_add_f32 v138, v138, v148
  v_add_f32 v134, v134, v149
  v_add_f32 v135, v135, v150
  v_add_f32 v136, v136, v151
  v_add_f32 v138, v138, v152
  v_add_f32 v134, v134, v153
  v_add_f32 v135, v135, v154
  v_add_f32 v136, v136, v155
  v_add_f32 v138, v138, v134
  v_add_f32 v135, v135, v136
  s_nop 0
  v_add_f32 v138, v138, v135
  s_nop 0
  v_mov_b32 v134, v138
  s_nop 1
  v_permlane32_swap_b32 v138, v134
  s_nop 0
  v_add_f32 v138, v138, v134
  s_nop 0
  v_mul_f32 v137, 0xbd000000, v138
  s_nop 0
  v_add_f32 v140, v140, v137
  v_add_f32 v141, v141, v137
  v_add_f32 v142, v142, v137
  v_add_f32 v143, v143, v137
  v_add_f32 v144, v144, v137
  v_add_f32 v145, v145, v137
  v_add_f32 v146, v146, v137
  v_add_f32 v147, v147, v137
  v_add_f32 v148, v148, v137
  v_add_f32 v149, v149, v137
  v_add_f32 v150, v150, v137
  v_add_f32 v151, v151, v137
  v_add_f32 v152, v152, v137
  v_add_f32 v153, v153, v137
  v_add_f32 v154, v154, v137
  v_add_f32 v155, v155, v137
  v_mul_f32 v139, v140, v140
  v_mul_f32 v134, v141, v141
  v_mul_f32 v135, v142, v142
  v_mul_f32 v136, v143, v143
  v_fmac_f32 v139, v144, v144
  v_fmac_f32 v134, v145, v145
  v_fmac_f32 v135, v146, v146
  v_fmac_f32 v136, v147, v147
  v_fmac_f32 v139, v148, v148
  v_fmac_f32 v134, v149, v149
  v_fmac_f32 v135, v150, v150
  v_fmac_f32 v136, v151, v151
  v_fmac_f32 v139, v152, v152
  v_fmac_f32 v134, v153, v153
  v_fmac_f32 v135, v154, v154
  v_fmac_f32 v136, v155, v155
  v_add_f32 v139, v139, v134
  v_add_f32 v135, v135, v136
  s_nop 0
  v_add_f32 v139, v139, v135
  s_nop 0
  v_mov_b32 v134, v139
  s_nop 1
  v_permlane32_swap_b32 v139, v134
  s_nop 0
  v_add_f32 v139, v139, v134
  s_cmp_lg_u32 s16, 0
  s_cbranch_scc1 st___prompt_30
  buffer_store_dwordx2 v[138:139], v7, s[4:7], s83 offen
  s_branch sd___prompt_31
st___prompt_30:
  buffer_store_dwordx2 v[138:139], v7, s[4:7], s83 offen sc1
sd___prompt_31:
  s_waitcnt vmcnt(0)
  s_barrier
  s_add_u32 s17, s17, 1
  s_cmp_lg_u32 s12, 0
  s_cbranch_scc1 hop___prompt_32
  s_lshl_b32 s45, s14, 2
  s_add_u32 s45, s45, s37
  v_mov_b32 v10, s17
  v_mov_b32 v11, 0
  s_mov_b64 exec, 1
  s_cmp_lg_u32 s16, 0
  s_cbranch_scc1 fs___prompt_33
  buffer_store_dword v10, v11, s[4:7], s45 offen
  s_branch fd___prompt_34
fs___prompt_33:
  buffer_store_dword v10, v11, s[4:7], s45 offen sc1
fd___prompt_34:
  s_mov_b64 exec, -1
  s_mov_b32 s46, 0
poll___prompt_35:
  s_add_u32 s46, s46, 1
  s_cmp_gt_u32 s46, 4194304
  s_cbranch_scc1 pollt___prompt_37
  buffer_load_dword v9, v8, s[4:7], s37 offen sc1
  s_waitcnt vmcnt(0)
  v_subrev_u32 v10, s17, v9
  v_cmp_le_u32 vcc, 8, v10
  s_cbranch_vccz pollx___prompt_36
  s_branch poll___prompt_35
pollt___prompt_37:
  s_mov_b32 s18, 1
pollx___prompt_36:
hop___prompt_32:
  s_barrier
  s_lshl_b32 s44, s12, 15
  s_add_u32 s44, s44, s29
  buffer_load_dwordx4 a[0:3], v1, s[4:7], s44 offen offset:0 sc1
  buffer_load_dwordx4 a[4:7], v1, s[4:7], s44 offen offset:1024 sc1
  ds_read_b128 v[208:211], v3 offset:0
  ds_read_b128 v[212:215], v4 offset:0
  ds_read_b128 v[216:219], v3 offset:1024
  ds_read_b128 v[220:223], v4 offset:1024
  buffer_load_dwordx4 a[8:11], v1, s[4:7], s44 offen offset:2048 sc1
  buffer_load_dwordx4 a[12:15], v1, s[4:7], s44 offen offset:3072 sc1
  s_lshl_b32 s52, s12, 12
  s_add_u32 s52, s52, s30
  buffer_load_dwordx4 v[116:119], v1, s[4:7], s52 offen offset:0 sc1
  buffer_load_dwordx4 v[120:123], v1, s[4:7], s52 offen offset:1024 sc1
  buffer_load_dwordx4 v[124:127], v1, s[4:7], s52 offen offset:2048 sc1
  buffer_load_dwordx4 v[128:131], v1, s[4:7], s52 offen offset:3072 sc1
  s_add_u32 s44, s44, 4096
  buffer_load_dwordx4 a[16:19], v1, s[4:7], s44 offen offset:0 sc1
  buffer_load_dwordx4 a[20:23], v1, s[4:7], s44 offen offset:1024 sc1
  buffer_load_dwordx4 a[24:27], v1, s[4:7], s44 offen offset:2048 sc1
  buffer_load_dwordx4 a[28:31], v1, s[4:7], s44 offen offset:3072 sc1
  s_add_u32 s44, s44, 4096
  buffer_load_dwordx4 a[32:35], v1, s[4:7], s44 offen offset:0 sc1
  buffer_load_dwordx4 a[36:39], v1, s[4:7], s44 offen offset:1024 sc1
  s_waitcnt vmcnt(13) lgkmcnt(2)
  v_mfma_f32_32x32x16_bf16 v[16:31], v[208:211], a[0:3], 0
  ds_read_b128 v[224:227], v3 offset:2048
  v_mfma_f32_32x32x16_bf16 v[32:47], v[212:215], a[0:3], 0
  ds_read_b128 v[228:231], v4 offset:2048
  buffer_load_dwordx4 a[40:43], v1, s[4:7], s44 offen offset:2048 sc1
  s_waitcnt vmcnt(13) lgkmcnt(2)
  v_mfma_f32_32x32x16_bf16 v[16:31], v[216:219], a[4:7], v[16:31]
  ds_read_b128 v[208:211], v3 offset:3072
  v_mfma_f32_32x32x16_bf16 v[32:47], v[220:223], a[4:7], v[32:47]
  ds_read_b128 v[212:215], v4 offset:3072
  buffer_load_dwordx4 a[44:47], v1, s[4:7], s44 offen offset:3072 sc1
  s_waitcnt vmcnt(13) lgkmcnt(2)
  v_mfma_f32_32x32x16_bf16 v[16:31], v[224:227], a[8:11], v[16:31]
  ds_read_b128 v[216:219], v3 offset:4096
  v_mfma_f32_32x32x16_bf16 v[32:47], v[228:231], a[8:11], v[32:47]
  ds_read_b128 v[220:223], v4 offset:4096
  s_add_u32 s44, s44, 4096
  buffer_load_dwordx4 a[48:51], v1, s[4:7], s44 offen offset:0 sc1
  s_waitcnt vmcnt(13) lgkmcnt(2)
  v_mfma_f32_32x32x16_bf16 v[16:31], v[208:211], a[12:15], v[16:31]
  ds_read_b128 v[224:227], v3 offset:5120
  s_waitcnt vmcnt(9)
  v_add_f32 v132, v116, v118
  v_add_f32 v133, v120, v122
  v_mfma_f32_32x32x16_bf16 v[32:47], v[212:215], a[12:15], v[32:47]
  ds_read_b128 v[228:231], v4 offset:5120
  buffer_load_dwordx4 a[52:55], v1, s[4:7], s44 offen offset:1024 sc1
  v_add_f32 v134, v117, v119
  s_waitcnt vmcnt(9) lgkmcnt(2)
  v_mfma_f32_32x32x16_bf16 v[16:31], v[216:219], a[16:19], v[16:31]
  ds_read_b128 v[208:211], v3 offset:6144
  v_add_f32 v135, v121, v123
  v_add_f32 v132, v132, v124
  v_add_f32 v133, v133, v126
  v_mfma_f32_32x32x16_bf16 v[32:47], v[220:223], a[16:19], v[32:47]
  ds_read_b128 v[212:215], v4 offset:6144
  buffer_load_dwordx4 a[56:59], v1, s[4:7], s44 offen offset:2048 sc1
  v_add_f32 v134, v134, v125
  s_waitcnt vmcnt(9) lgkmcnt(2)
  v_mfma_f32_32x32x16_bf16 v[16:31], v[224:227], a[20:23], v[16:31]
  ds_read_b128 v[216:219], v3 offset:7168
  v_add_f32 v135, v135, v127
  v_add_f32 v132, v132, v128
  v_add_f32 v133, v133, v130
  v_mfma_f32_32x32x16_bf16 v[32:47], v[228:231], a[20:23], v[32:47]
  ds_read_b128 v[220:223], v4 offset:7168
  buffer_load_dwordx4 a[60:63], v1, s[4:7], s44 offen offset:3072 sc1
  v_add_f32 v134, v134, v129
  s_waitcnt vmcnt(9) lgkmcnt(2)
  v_mfma_f32_32x32x16_bf16 v[16:31], v[208:211], a[24:27], v[16:31]
  ds_read_b128 v[224:227], v3 offset:8192
  v_add_f32 v135, v135, v131
  v_add_f32 v132, v132, v133
  v_add_f32 v134, v134, v135
  v_mfma_f32_32x32x16_bf16 v[32:47], v[212:215], a[24:27], v[32:47]
  ds_read_b128 v[228:231], v4 offset:8192
  s_add_u32 s44, s44, 4096
  buffer_load_dwordx4 a[64:67], v1, s[4:7], s44 offen offset:0 sc1
  v_mov_b32 v133, v132
  s_waitcnt vmcnt(9) lgkmcnt(2)
  v_mfma_f32_32x32x16_bf16 v[16:31], v[216:219], a[28:31], v[16:31]
  ds_read_b128 v[208:211], v3 offset:9216
  s_nop 1
  v_permlane32_swap_b32 v132, v133
  v_add_f32 v132, v132, v133
  v_mfma_f32_32x32x16_bf16 v[32:47], v[220:223], a[28:31], v[32:47]
  ds_read_b128 v[212:215], v4 offset:9216
  buffer_load_dwordx4 a[68:71], v1, s[4:7], s44 offen offset:1024 sc1
  v_mul_f32 v132, 0x3b000000, v132
  s_waitcnt vmcnt(9) lgkmcnt(2)
  v_mfma_f32_32x32x16_bf16 v[16:31], v[224:227], a[32:35], v[16:31]
  ds_read_b128 v[216:219], v3 offset:10240
  v_mov_b32 v136, 0x3d000000
  v_fma_f32 v116, v116, v136, -v132
  v_fma_f32 v118, v118, v136, -v132
  v_mfma_f32_32x32x16_bf16 v[32:47], v[228:231], a[32:35], v[32:47]
  ds_read_b128 v[220:223], v4 offset:10240
  buffer_load_dwordx4 a[72:75], v1, s[4:7], s44 offen offset:2048 sc1
  v_fma_f32 v120, v120, v136, -v132
  s_waitcnt vmcnt(9) lgkmcnt(2)
  v_mfma_f32_32x32x16_bf16 v[16:31], v[208:211], a[36:39], v[16:31]
  ds_read_b128 v[224:227], v3 offset:11264
  v_fma_f32 v122, v122, v136, -v132
  v_fma_f32 v124, v124, v136, -v132
  v_fma_f32 v126, v126, v136, -v132
  v_mfma_f32_32x32x16_bf16 v[32:47], v[212:215], a[36:39], v[32:47]
  ds_read_b128 v[228:231], v4 offset:11264
  buffer_load_dwordx4 a[76:79], v1, s[4:7], s44 offen offset:3072 sc1
  v_fma_f32 v128, v128, v136, -v132
  s_waitcnt vmcnt(9) lgkmcnt(2)
  v_mfma_f32_32x32x16_bf16 v[16:31], v[216:219], a[40:43], v[16:31]
  ds_read_b128 v[208:211], v3 offset:12288
  v_fma_f32 v130, v130, v136, -v132
  v_mul_f32 v133, v116, v116
  v_mul_f32 v135, v118, v118
  v_mfma_f32_32x32x16_bf16 v[32:47], v[220:223], a[40:43], v[32:47]
  ds_read_b128 v[212:215], v4 offset:12288
  s_add_u32 s44, s44, 4096
  buffer_load_dwordx4 a[80:83], v1, s[4:7], s44 offen offset:0 sc1
  v_fmac_f32 v133, v120, v120
  s_waitcnt vmcnt(9) lgkmcnt(2)
  v_mfma_f32_32x32x16_bf16 v[16:31], v[224:227], a[44:47], v[16:31]
  ds_read_b128 v[216:219], v3 offset:13312
  v_fmac_f32 v135, v122, v122
  v_fmac_f32 v133, v124, v124
  v_fmac_f32 v135, v126, v126
  v_mfma_f32_32x32x16_bf16 v[32:47], v[228:231], a[44:47], v[32:47]
  ds_read_b128 v[220:223], v4 offset:13312
  buffer_load_dwordx4 a[84:87], v1, s[4:7], s44 offen offset:1024 sc1
  v_fmac_f32 v133, v128, v128
  s_waitcnt vmcnt(9) lgkmcnt(2)
  v_mfma_f32_32x32x16_bf16 v[16:31], v[208:211], a[48:51], v[16:31]
  ds_read_b128 v[224:227], v3 offset:14336
  v_fmac_f32 v135, v130, v130
  v_add_f32 v133, v133, v135
  v_mov_b32 v136, 0x42000000
  v_mfma_f32_32x32x16_bf16 v[32:47], v[212:215], a[48:51], v[32:47]
  ds_read_b128 v[228:231], v4 offset:14336
  buffer_load_dwordx4 a[88:91], v1, s[4:7], s44 offen offset:2048 sc1
  v_fmac_f32 v134, v136, v133
  s_waitcnt vmcnt(9) lgkmcnt(2)
  v_mfma_f32_32x32x16_bf16 v[16:31], v[216:219], a[52:55], v[16:31]
  ds_read_b128 v[208:211], v3 offset:15360
  v_mov_b32 v133, v134
  v_sub_f32 v132, 0, v132
  s_nop 0
  v_mfma_f32_32x32x16_bf16 v[32:47], v[220:223], a[52:55], v[32:47]
  ds_read_b128 v[212:215], v4 offset:15360
  buffer_load_dwordx4 a[92:95], v1, s[4:7], s44 offen offset:3072 sc1
  v_permlane32_swap_b32 v134, v133
  s_waitcnt vmcnt(9) lgkmcnt(2)
  v_mfma_f32_32x32x16_bf16 v[16:31], v[224:227], a[56:59], v[16:31]
  ds_read_b128 v[216:219], v3 offset:16384
  v_add_f32 v134, v134, v133
  v_mov_b32 v135, 0x3727c5ac
  v_fmac_f32 v135, 0x3b000000, v134
  v_mfma_f32_32x32x16_bf16 v[32:47], v[228:231], a[56:59], v[32:47]
  ds_read_b128 v[220:223], v4 offset:16384
  s_add_u32 s44, s44, 4096
  buffer_load_dwordx4 a[96:99], v1, s[4:7], s44 offen offset:0 sc1
  v_cvt_pk_bf16_f32 v108, v132, v132
  s_waitcnt vmcnt(9) lgkmcnt(2)
  v_mfma_f32_32x32x16_bf16 v[16:31], v[208:211], a[60:63], v[16:31]
  ds_read_b128 v[224:227], v3 offset:17408
  v_rsq_f32 v104, v135
  v_lshlrev_b32 v133, 16, v108
  v_sub_f32 v133, v132, v133
  v_mfma_f32_32x32x16_bf16 v[32:47], v[212:215], a[60:63], v[32:47]
  ds_read_b128 v[228:231], v4 offset:17408
  buffer_load_dwordx4 a[100:103], v1, s[4:7], s44 offen offset:1024 sc1
  v_mul_f32 v105, 0xbfb8aa3b, v104
  s_waitcnt vmcnt(9) lgkmcnt(2)
  v_mfma_f32_32x32x16_bf16 v[16:31], v[216:219], a[64:67], v[16:31]
  ds_read_b128 v[208:211], v3 offset:18432
  v_mov_b32 v106, v135
  v_cvt_pk_bf16_f32 v109, v133, v133
  v_mfma_f32_32x32x16_bf16 v[32:47], v[220:223], a[64:67], v[32:47]
  ds_read_b128 v[212:215], v4 offset:18432
  buffer_load_dwordx4 a[104:107], v1, s[4:7], s44 offen offset:2048 sc1
  s_waitcnt vmcnt(9) lgkmcnt(2)
  v_mfma_f32_32x32x16_bf16 v[16:31], v[224:227], a[68:71], v[16:31]
  ds_read_b128 v[216:219], v3 offset:19456
  v_mfma_f32_32x32x16_bf16 v[32:47], v[228:231], a[68:71], v[32:47]
  ds_read_b128 v[220:223], v4 offset:19456
  buffer_load_dwordx4 a[108:111], v1, s[4:7], s44 offen offset:3072 sc1
  s_waitcnt vmcnt(9) lgkmcnt(2)
  v_mfma_f32_32x32x16_bf16 v[16:31], v[208:211], a[72:75], v[16:31]
  ds_read_b128 v[224:227], v3 offset:20480
  v_mfma_f32_32x32x16_bf16 v[32:47], v[212:215], a[72:75], v[32:47]
  ds_read_b128 v[228:231], v4 offset:20480
  s_add_u32 s44, s44, 4096
  buffer_load_dwordx4 a[112:115], v1, s[4:7], s44 offen offset:0 sc1
  s_waitcnt vmcnt(9) lgkmcnt(2)
  v_mfma_f32_32x32x16_bf16 v[16:31], v[216:219], a[76:79], v[16:31]
  ds_read_b128 v[208:211], v3 offset:21504
  v_mfma_f32_32x32x16_bf16 v[32:47], v[220:223], a[76:79], v[32:47]
  ds_read_b128 v[212:215], v4 offset:21504
  buffer_load_dwordx4 a[116:119], v1, s[4:7], s44 offen offset:1024 sc1
  s_waitcnt vmcnt(9) lgkmcnt(2)
  v_mfma_f32_32x32x16_bf16 v[16:31], v[224:227], a[80:83], v[16:31]
  ds_read_b128 v[216:219], v3 offset:22528
  v_mfma_f32_32x32x16_bf16 v[32:47], v[228:231], a[80:83], v[32:47]
  ds_read_b128 v[220:223], v4 offset:22528
  buffer_load_dwordx4 a[120:123], v1, s[4:7], s44 offen offset:2048 sc1
  s_waitcnt vmcnt(9) lgkmcnt(2)
  v_mfma_f32_32x32x16_bf16 v[16:31], v[208:211], a[84:87], v[16:31]
  ds_read_b128 v[224:227], v3 offset:23552
  v_mfma_f32_32x32x16_bf16 v[32:47], v[212:215], a[84:87], v[32:47]
  ds_read_b128 v[228:231], v4 offset:23552
  buffer_load_dwordx4 a[124:127], v1, s[4:7], s44 offen offset:3072 sc1
  s_waitcnt vmcnt(9) lgkmcnt(2)
  v_mfma_f32_32x32x16_bf16 v[16:31], v[216:219], a[88:91], v[16:31]
  ds_read_b128 v[208:211], v3 offset:24576
  v_mfma_f32_32x32x16_bf16 v[32:47], v[220:223], a[88:91], v[32:47]
  ds_read_b128 v[212:215], v4 offset:24576
  s_add_u32 s42, s20, s24
  s_add_u32 s43, s27, s24
  s_add_u32 s43, s43, 101376
  s_mov_b32 m0, s42
  s_nop 0
  buffer_load_dwordx4 v1, s[4:7], s43 offen offset:0 lds
  buffer_load_dwordx4 v1, s[4:7], s43 offen offset:1024 lds
  s_waitcnt vmcnt(10) lgkmcnt(2)
  v_mfma_f32_32x32x16_bf16 v[16:31], v[224:227], a[92:95], v[16:31]
  ds_read_b128 v[216:219], v3 offset:25600
  v_mfma_f32_32x32x16_bf16 v[32:47], v[228:231], a[92:95], v[32:47]
  ds_read_b128 v[220:223], v4 offset:25600
  buffer_load_dwordx4 v1, s[4:7], s43 offen offset:2048 lds
  buffer_load_dwordx4 v1, s[4:7], s43 offen offset:3072 lds
  s_waitcnt vmcnt(11) lgkmcnt(2)
  v_mfma_f32_32x32x16_bf16 v[16:31], v[208:211], a[96:99], v[16:31]
  ds_read_b128 v[224:227], v3 offset:26624
  v_mfma_f32_32x32x16_bf16 v[32:47], v[212:215], a[96:99], v[32:47]
  ds_read_b128 v[228:231], v4 offset:26624
  s_add_u32 m0, s42, 4096
  s_add_u32 s43, s43, 4096
  buffer_load_dwordx4 v1, s[4:7], s43 offen offset:0 lds
  buffer_load_dwordx4 v1, s[4:7], s43 offen offset:1024 lds
  s_waitcnt vmcnt(12) lgkmcnt(2)
  v_mfma_f32_32x32x16_bf16 v[16:31], v[216:219], a[100:103], v[16:31]
  ds_read_b128 v[208:211], v3 offset:27648
  v_mfma_f32_32x32x16_bf16 v[32:47], v[220:223], a[100:103], v[32:47]
  ds_read_b128 v[212:215], v4 offset:27648
  buffer_load_dwordx4 v1, s[4:7], s43 offen offset:2048 lds
  buffer_load_dwordx4 v1, s[4:7], s43 offen offset:3072 lds
  s_waitcnt vmcnt(13) lgkmcnt(2)
  v_mfma_f32_32x32x16_bf16 v[16:31], v[224:227], a[104:107], v[16:31]
  ds_read_b128 v[216:219], v3 offset:28672
  v_mfma_f32_32x32x16_bf16 v[32:47], v[228:231], a[104:107], v[32:47]
  ds_read_b128 v[220:223], v4 offset:28672
  s_add_u32 s57, s28, s24
  s_add_u32 s57, s57, 98304
  s_mov_b64 exec, s[94:95]
  buffer_load_dwordx4 a[128:131], v1, s[4:7], s57 offen offset:0
  s_mov_b64 exec, -1
  s_mov_b64 exec, s[94:95]
  buffer_load_dwordx4 a[132:135], v1, s[4:7], s57 offen offset:1024
  s_mov_b64 exec, -1
  s_waitcnt vmcnt(14) lgkmcnt(2)
  v_mfma_f32_32x32x16_bf16 v[16:31], v[208:211], a[108:111], v[16:31]
  ds_read_b128 v[224:227], v3 offset:29696
  v_mfma_f32_32x32x16_bf16 v[32:47], v[212:215], a[108:111], v[32:47]
  ds_read_b128 v[228:231], v4 offset:29696
  s_mov_b64 exec, s[94:95]
  buffer_load_dwordx4 a[136:139], v1, s[4:7], s57 offen offset:2048
  s_mov_b64 exec, -1
  s_mov_b64 exec, s[94:95]
  buffer_load_dwordx4 a[140:143], v1, s[4:7], s57 offen offset:3072
  s_mov_b64 exec, -1
  s_waitcnt vmcnt(15) lgkmcnt(2)
  v_mfma_f32_32x32x16_bf16 v[16:31], v[216:219], a[112:115], v[16:31]
  ds_read_b128 v[208:211], v3 offset:30720
  v_mfma_f32_32x32x16_bf16 v[32:47], v[220:223], a[112:115], v[32:47]
  ds_read_b128 v[212:215], v4 offset:30720
  s_add_u32 s57, s57, 4096
  s_mov_b64 exec, s[94:95]
  buffer_load_dwordx4 a[144:147], v1, s[4:7], s57 offen offset:0
  s_mov_b64 exec, -1
  s_mov_b64 exec, s[94:95]
  buffer_load_dwordx4 a[148:151], v1, s[4:7], s57 offen offset:1024
  s_mov_b64 exec, -1
  s_waitcnt vmcnt(16) lgkmcnt(2)
  v_mfma_f32_32x32x16_bf16 v[16:31], v[224:227], a[116:119], v[16:31]
  ds_read_b128 v[216:219], v3 offset:31744
  v_mfma_f32_32x32x16_bf16 v[32:47], v[228:231], a[116:119], v[32:47]
  ds_read_b128 v[220:223], v4 offset:31744
  s_mov_b64 exec, s[94:95]
  buffer_load_dwordx4 a[152:155], v1, s[4:7], s57 offen offset:2048
  s_mov_b64 exec, -1
  s_mov_b64 exec, s[94:95]
  buffer_load_dwordx4 a[156:159], v1, s[4:7], s57 offen offset:3072
  s_mov_b64 exec, -1
  v_mov_b32 v84, v77
  v_mov_b32 v85, v77
  v_mov_b32 v204, v78
  v_mov_b32 v205, v78
  s_waitcnt vmcnt(17) lgkmcnt(2)
  v_mfma_f32_32x32x16_bf16 v[16:31], v[208:211], a[120:123], v[16:31]
  v_mfma_f32_32x32x16_bf16 v[32:47], v[212:215], a[120:123], v[32:47]
  s_waitcnt vmcnt(16) lgkmcnt(0)
  v_mfma_f32_32x32x16_bf16 v[16:31], v[216:219], a[124:127], v[16:31]
  v_mfma_f32_32x32x16_bf16 v[32:47], v[220:223], a[124:127], v[32:47]
  s_nop 1
  v_mfma_f32_32x32x16_bf16 v[16:31], v[84:87], v[108:111], v[16:31]
  v_mfma_f32_32x32x16_bf16 v[32:47], v[204:207], v[108:111], v[32:47]
  s_barrier
  ds_read_b128 v[208:211], v5 offset:0
  ds_read_b128 v[212:215], v5 offset:1024
  ds_read_b128 v[216:219], v5 offset:2048
  ds_read_b128 v[220:223], v5 offset:3072
  ds_read_b128 v[224:227], v5 offset:4096
  ds_read_b128 v[228:231], v5 offset:5120
  ds_read_b128 v[232:235], v5 offset:6144
  ds_read_b128 v[236:239], v5 offset:7168
  s_waitcnt lgkmcnt(4)
  v_mfma_f32_32x32x16_bf16 v[48:63], v[208:211], a[0:3], 0
  s_add_u32 s42, s21, s24
  s_add_u32 s43, s27, s24
  s_add_u32 s43, s43, 135168
  s_mov_b32 m0, s42
  s_nop 0
  buffer_load_dwordx4 v1, s[4:7], s43 offen offset:0 lds
  ds_read_b128 v[240:243], v5 offset:8192
  v_mfma_f32_32x32x16_bf16 v[48:63], v[212:215], a[4:7], v[48:63]
  ds_read_b128 v[244:247], v5 offset:9216
  v_mfma_f32_32x32x16_bf16 v[48:63], v[216:219], a[8:11], v[48:63]
  buffer_load_dwordx4 v1, s[4:7], s43 offen offset:1024 lds
  ds_read_b128 v[208:211], v5 offset:10240
  v_mfma_f32_32x32x16_bf16 v[48:63], v[220:223], a[12:15], v[48:63]
  ds_read_b128 v[212:215], v5 offset:11264
  s_waitcnt lgkmcnt(4)
  v_mfma_f32_32x32x16_bf16 v[48:63], v[224:227], a[16:19], v[48:63]
  buffer_load_dwordx4 v1, s[4:7], s43 offen offset:2048 lds
  v_mul_f32 v148, v16, v105
  v_mul_f32 v149, v17, v105
  v_mul_f32 v150, v18, v105
  v_mul_f32 v151, v19, v105
  v_mul_f32 v152, v20, v105
  v_mul_f32 v153, v21, v105
  v_mul_f32 v154, v22, v105
  v_mul_f32 v155, v23, v105
  v_mul_f32 v140, v16, v24
  v_mul_f32 v141, v17, v25
  ds_read_b128 v[216:219], v5 offset:12288
  v_mfma_f32_32x32x16_bf16 v[48:63], v[228:231], a[20:23], v[48:63]
  v_mul_f32 v142, v18, v26
  v_mul_f32 v143, v19, v27
  ds_read_b128 v[220:223], v5 offset:13312
  v_mfma_f32_32x32x16_bf16 v[48:63], v[232:235], a[24:27], v[48:63]
  buffer_load_dwordx4 v1, s[4:7], s43 offen offset:3072 lds
  v_mul_f32 v144, v20, v28
  v_mul_f32 v145, v21, v29
  ds_read_b128 v[224:227], v5 offset:14336
  v_mfma_f32_32x32x16_bf16 v[48:63], v[236:239], a[28:31], v[48:63]
  v_mul_f32 v146, v22, v30
  v_mul_f32 v147, v23, v31
  ds_read_b128 v[228:231], v5 offset:15360
  s_waitcnt lgkmcnt(4)
  v_mfma_f32_32x32x16_bf16 v[48:63], v[240:243], a[32:35], v[48:63]
  s_add_u32 m0, s42, 4096
  s_add_u32 s43, s43, 4096
  buffer_load_dwordx4 v1, s[4:7], s43 offen offset:0 lds
  v_exp_f32 v148, v148
  v_exp_f32 v149, v149
  ds_read_b128 v[232:235], v5 offset:16384
  v_mfma_f32_32x32x16_bf16 v[48:63], v[244:247], a[36:39], v[48:63]
  v_exp_f32 v150, v150
  v_exp_f32 v151, v151
  ds_read_b128 v[236:239], v5 offset:17408
  v_mfma_f32_32x32x16_bf16 v[48:63], v[208:211], a[40:43], v[48:63]
  buffer_load_dwordx4 v1, s[4:7], s43 offen offset:1024 lds
  v_exp_f32 v152, v152
  v_exp_f32 v153, v153
  ds_read_b128 v[240:243], v5 offset:18432
  v_mfma_f32_32x32x16_bf16 v[48:63], v[212:215], a[44:47], v[48:63]
  v_exp_f32 v154, v154
  v_exp_f32 v155, v155
  ds_read_b128 v[244:247], v5 offset:19456
  s_waitcnt lgkmcnt(4)
  v_mfma_f32_32x32x16_bf16 v[48:63], v[216:219], a[48:51], v[48:63]
  buffer_load_dwordx4 v1, s[4:7], s43 offen offset:2048 lds
  v_fma_f32 v148, v148, v106, v106
  v_fma_f32 v149, v149, v106, v106
  ds_read_b128 v[208:211], v5 offset:20480
  v_mfma_f32_32x32x16_bf16 v[48:63], v[220:223], a[52:55], v[48:63]
  v_fma_f32 v150, v150, v106, v106
  v_fma_f32 v151, v151, v106, v106
  ds_read_b128 v[212:215], v5 offset:21504
  v_mfma_f32_32x32x16_bf16 v[48:63], v[224:227], a[56:59], v[48:63]
  buffer_load_dwordx4 v1, s[4:7], s43 offen offset:3072 lds
  v_fma_f32 v152, v152, v106, v106
  v_fma_f32 v153, v153, v106, v106
  ds_read_b128 v[216:219], v5 offset:22528
  v_mfma_f32_32x32x16_bf16 v[48:63], v[228:231], a[60:63], v[48:63]
  v_fma_f32 v154, v154, v106, v106
  v_fma_f32 v155, v155, v106, v106
  ds_read_b128 v[220:223], v5 offset:23552
  s_waitcnt lgkmcnt(4)
  v_mfma_f32_32x32x16_bf16 v[48:63], v[232:235], a[64:67], v[48:63]
  s_add_u32 s42, s22, s24
  s_add_u32 s43, s27, s24
  s_add_u32 s43, s43, 168960
  s_mov_b32 m0, s42
  s_nop 0
  buffer_load_dwordx4 v1, s[4:7], s43 offen offset:0 lds
  v_rcp_f32 v148, v148
  v_rcp_f32 v149, v149
  ds_read_b128 v[224:227], v5 offset:24576
  v_mfma_f32_32x32x16_bf16 v[48:63], v[236:239], a[68:71], v[48:63]
  v_rcp_f32 v150, v150
  v_rcp_f32 v151, v151
  ds_read_b128 v[228:231], v5 offset:25600
  v_mfma_f32_32x32x16_bf16 v[48:63], v[240:243], a[72:75], v[48:63]
  buffer_load_dwordx4 v1, s[4:7], s43 offen offset:1024 lds
  v_rcp_f32 v152, v152
  v_rcp_f32 v153, v153
  ds_read_b128 v[232:235], v5 offset:26624
  v_mfma_f32_32x32x16_bf16 v[48:63], v[244:247], a[76:79], v[48:63]
  v_rcp_f32 v154, v154
  v_rcp_f32 v155, v155
  ds_read_b128 v[236:239], v5 offset:27648
  s_waitcnt lgkmcnt(4)
  v_mfma_f32_32x32x16_bf16 v[48:63], v[208:211], a[80:83], v[48:63]
  buffer_load_dwordx4 v1, s[4:7], s43 offen offset:2048 lds
  s_add_u32 s51, s85, 0
  v_mul_f32 v140, v140, v148
  ds_read_b128 v[240:243], v5 offset:28672
  v_mfma_f32_32x32x16_bf16 v[48:63], v[212:215], a[84:87], v[48:63]
  v_mul_f32 v141, v141, v149
  v_mul_f32 v142, v142, v150
  ds_read_b128 v[244:247], v5 offset:29696
  v_mfma_f32_32x32x16_bf16 v[48:63], v[216:219], a[88:91], v[48:63]
  buffer_load_dwordx4 v1, s[4:7], s43 offen offset:3072 lds
  v_mul_f32 v143, v143, v151
  v_mul_f32 v144, v144, v152
  ds_read_b128 v[208:211], v5 offset:30720
  v_mfma_f32_32x32x16_bf16 v[48:63], v[220:223], a[92:95], v[48:63]
  v_mul_f32 v145, v145, v153
  v_mul_f32 v146, v146, v154
  ds_read_b128 v[212:215], v5 offset:31744
  s_waitcnt lgkmcnt(4)
  v_mfma_f32_32x32x16_bf16 v[48:63], v[224:227], a[96:99], v[48:63]
  s_add_u32 m0, s42, 4096
  s_add_u32 s43, s43, 4096
  buffer_load_dwordx4 v1, s[4:7], s43 offen offset:0 lds
  v_mul_f32 v147, v147, v155
  v_cvt_pk_bf16_f32 v156, v140, v141
  s_waitcnt vmcnt(21)
  s_barrier
  v_mfma_f32_32x32x16_bf16 v[48:63], v[228:231], a[100:103], v[48:63]
  v_cvt_pk_bf16_f32 v157, v142, v143
  v_cvt_pk_bf16_f32 v158, v144, v145
  ds_read_b128 v[220:223], v2 offset:0
  v_mfma_f32_32x32x16_bf16 v[48:63], v[232:235], a[104:107], v[48:63]
  buffer_load_dwordx4 v1, s[4:7], s43 offen offset:1024 lds
  v_cvt_pk_bf16_f32 v159, v146, v147
  buffer_store_dwordx4 v[156:159], v1, s[4:7], s51 offen sc1
  ds_read_b128 v[224:227], v2 offset:1024
  v_mfma_f32_32x32x16_bf16 v[48:63], v[236:239], a[108:111], v[48:63]
  v_mul_f32 v148, v32, v105
  v_mul_f32 v149, v33, v105
  ds_read_b128 v[228:231], v2 offset:2048
  s_waitcnt lgkmcnt(3)
  v_mov_b32 v84, v79
  v_mov_b32 v85, v79
  v_mfma_f32_32x32x16_bf16 v[48:63], v[240:243], a[112:115], v[48:63]
  buffer_load_dwordx4 v1, s[4:7], s43 offen offset:2048 lds
  v_mul_f32 v150, v34, v105
  v_mul_f32 v151, v35, v105
  ds_read_b128 v[232:235], v2 offset:3072
  v_mfma_f32_32x32x16_bf16 v[48:63], v[244:247], a[116:119], v[48:63]
  v_mul_f32 v152, v36, v105
  v_mul_f32 v153, v37, v105
  ds_read_b128 v[236:239], v2 offset:4096
  v_mfma_f32_32x32x16_bf16 v[48:63], v[208:211], a[120:123], v[48:63]
  buffer_load_dwordx4 v1, s[4:7], s43 offen offset:3072 lds
  v_mul_f32 v154, v38, v105
  v_mul_f32 v155, v39, v105
  ds_read_b128 v[240:243], v2 offset:5120
  v_mfma_f32_32x32x16_bf16 v[48:63], v[212:215], a[124:127], v[48:63]
  v_mul_f32 v140, v32, v40
  v_mul_f32 v141, v33, v41
  ds_read_b128 v[244:247], v2 offset:6144
  s_waitcnt lgkmcnt(4)
  v_mfma_f32_32x32x16_bf16 v[48:63], v[84:87], v[108:111], v[48:63]
  v_mul_f32 v142, v34, v42
  v_mul_f32 v143, v35, v43
  ds_read_b128 v[208:211], v2 offset:7168
  v_mfma_f32_32x32x16_bf16 v[16:31], v[220:223], a[0:3], 0
  v_mul_f32 v144, v36, v44
  v_mul_f32 v145, v37, v45
  s_barrier
  ds_read_b128 v[212:215], v2 offset:8192
  v_mfma_f32_32x32x16_bf16 v[16:31], v[224:227], a[4:7], v[16:31]
  s_add_u32 s42, s23, s24
  s_add_u32 s43, s27, s24
  s_add_u32 s43, s43, 202752
  s_mov_b32 m0, s42
  s_nop 0
  buffer_load_dwordx4 v1, s[4:7], s43 offen offset:0 lds
  v_mul_f32 v146, v38, v46
  v_mul_f32 v147, v39, v47
  ds_read_b128 v[216:219], v2 offset:9216
  v_mfma_f32_32x32x16_bf16 v[16:31], v[228:231], a[8:11], v[16:31]
  v_exp_f32 v148, v148
  v_exp_f32 v149, v149
  ds_read_b128 v[220:223], v2 offset:10240
  s_waitcnt lgkmcnt(4)
  v_mfma_f32_32x32x16_bf16 v[16:31], v[232:235], a[12:15], v[16:31]
  buffer_load_dwordx4 v1, s[4:7], s43 offen offset:1024 lds
  v_exp_f32 v150, v150
  v_exp_f32 v151, v151
  ds_read_b128 v[224:227], v2 offset:11264
  v_mfma_f32_32x32x16_bf16 v[16:31], v[236:239], a[16:19], v[16:31]
  v_exp_f32 v152, v152
  v_exp_f32 v153, v153
  ds_read_b128 v[228:231], v2 offset:12288
  v_mfma_f32_32x32x16_bf16 v[16:31], v[240:243], a[20:23], v[16:31]
  buffer_load_dwordx4 v1, s[4:7], s43 offen offset:2048 lds
  v_exp_f32 v154, v154
  v_exp_f32 v155, v155
  ds_read_b128 v[232:235], v2 offset:13312
  v_mfma_f32_32x32x16_bf16 v[16:31], v[244:247], a[24:27], v[16:31]
  v_fma_f32 v148, v148, v106, v106
  v_fma_f32 v149, v149, v106, v106
  ds_read_b128 v[236:239], v2 offset:14336
  s_waitcnt lgkmcnt(4)
  v_mfma_f32_32x32x16_bf16 v[16:31], v[208:211], a[28:31], v[16:31]
  buffer_load_dwordx4 v1, s[4:7], s43 offen offset:3072 lds
  v_fma_f32 v150, v150, v106, v106
  v_fma_f32 v151, v151, v106, v106
  ds_read_b128 v[240:243], v2 offset:15360
  v_mfma_f32_32x32x16_bf16 v[16:31], v[212:215], a[32:35], v[16:31]
  v_fma_f32 v152, v152, v106, v106
  v_fma_f32 v153, v153, v106, v106
  ds_read_b128 v[244:247], v2 offset:16384
  v_mfma_f32_32x32x16_bf16 v[16:31], v[216:219], a[36:39], v[16:31]
  s_add_u32 m0, s42, 4096
  s_add_u32 s43, s43, 4096
  buffer_load_dwordx4 v1, s[4:7], s43 offen offset:0 lds
  v_fma_f32 v154, v154, v106, v106
  v_fma_f32 v155, v155, v106, v106
  ds_read_b128 v[208:211], v2 offset:17408
  v_mfma_f32_32x32x16_bf16 v[16:31], v[220:223], a[40:43], v[16:31]
  v_rcp_f32 v148, v148
  v_rcp_f32 v149, v149
  ds_read_b128 v[212:215], v2 offset:18432
  s_waitcnt lgkmcnt(4)
  v_mfma_f32_32x32x16_bf16 v[16:31], v[224:227], a[44:47], v[16:31]
  buffer_load_dwordx4 v1, s[4:7], s43 offen offset:1024 lds
  v_rcp_f32 v150, v150
  v_rcp_f32 v151, v151
  ds_read_b128 v[216:219], v2 offset:19456
  v_mfma_f32_32x32x16_bf16 v[16:31], v[228:231], a[48:51], v[16:31]
  v_rcp_f32 v152, v152
  v_rcp_f32 v153, v153
  ds_read_b128 v[220:223], v2 offset:20480
  v_mfma_f32_32x32x16_bf16 v[16:31], v[232:235], a[52:55], v[16:31]
  buffer_load_dwordx4 v1, s[4:7], s43 offen offset:2048 lds
  v_rcp_f32 v154, v154
  v_rcp_f32 v155, v155
  ds_read_b128 v[224:227], v2 offset:21504
  v_mfma_f32_32x32x16_bf16 v[16:31], v[236:239], a[56:59], v[16:31]
  s_add_u32 s51, s85, 1024
  v_mul_f32 v140, v140, v148
  ds_read_b128 v[228:231], v2 offset:22528
  s_waitcnt lgkmcnt(4)
  v_mfma_f32_32x32x16_bf16 v[16:31], v[240:243], a[60:63], v[16:31]
  buffer_load_dwordx4 v1, s[4:7], s43 offen offset:3072 lds
  v_mul_f32 v141, v141, v149
  v_mul_f32 v142, v142, v150
  ds_read_b128 v[232:235], v2 offset:23552
  v_mfma_f32_32x32x16_bf16 v[16:31], v[244:247], a[64:67], v[16:31]
  v_mul_f32 v143, v143, v151
  v_mul_f32 v144, v144, v152
  ds_read_b128 v[236:239], v2 offset:24576
  v_mfma_f32_32x32x16_bf16 v[16:31], v[208:211], a[68:71], v[16:31]
  s_add_u32 s57, s28, s24
  s_add_u32 s57, s57, 131072
  s_mov_b64 exec, s[94:95]
  buffer_load_dwordx4 a[160:163], v1, s[4:7], s57 offen offset:0
  s_mov_b64 exec, -1
  v_mul_f32 v145, v145, v153
  v_mul_f32 v146, v146, v154
  ds_read_b128 v[240:243], v2 offset:25600
  v_mfma_f32_32x32x16_bf16 v[16:31], v[212:215], a[72:75], v[16:31]
  v_mul_f32 v147, v147, v155
  v_cvt_pk_bf16_f32 v156, v140, v141
  ds_read_b128 v[244:247], v2 offset:26624
  s_waitcnt lgkmcnt(4)
  v_mfma_f32_32x32x16_bf16 v[16:31], v[216:219], a[76:79], v[16:31]
  s_mov_b64 exec, s[94:95]
  buffer_load_dwordx4 a[164:167], v1, s[4:7], s57 offen offset:1024
  s_mov_b64 exec, -1
  v_cvt_pk_bf16_f32 v157, v142, v143
  v_cvt_pk_bf16_f32 v158, v144, v145
  ds_read_b128 v[208:211], v2 offset:27648
  v_mfma_f32_32x32x16_bf16 v[16:31], v[220:223], a[80:83], v[16:31]
  v_cvt_pk_bf16_f32 v159, v146, v147
  buffer_store_dwordx4 v[156:159], v1, s[4:7], s51 offen sc1
  ds_read_b128 v[212:215], v2 offset:28672
  v_mfma_f32_32x32x16_bf16 v[16:31], v[224:227], a[84:87], v[16:31]
  s_mov_b64 exec, s[94:95]
  buffer_load_dwordx4 a[168:171], v1, s[4:7], s57 offen offset:2048
  s_mov_b64 exec, -1
  v_mul_f32 v148, v48, v105
  v_mul_f32 v149, v49, v105
  ds_read_b128 v[216:219], v2 offset:29696
  v_mfma_f32_32x32x16_bf16 v[16:31], v[228:231], a[88:91], v[16:31]
  v_mul_f32 v150, v50, v105
  v_mul_f32 v151, v51, v105
  ds_read_b128 v[220:223], v2 offset:30720
  s_waitcnt lgkmcnt(4)
  v_mfma_f32_32x32x16_bf16 v[16:31], v[232:235], a[92:95], v[16:31]
  s_mov_b64 exec, s[94:95]
  buffer_load_dwordx4 a[172:175], v1, s[4:7], s57 offen offset:3072
  s_mov_b64 exec, -1
  v_mul_f32 v152, v52, v105
  v_mul_f32 v153, v53, v105
  ds_read_b128 v[224:227], v2 offset:31744
  v_mfma_f32_32x32x16_bf16 v[16:31], v[236:239], a[96:99], v[16:31]
  v_mul_f32 v154, v54, v105
  v_mul_f32 v155, v55, v105
  s_waitcnt vmcnt(22)
  s_barrier
  v_mfma_f32_32x32x16_bf16 v[16:31], v[240:243], a[100:103], v[16:31]
  s_add_u32 s57, s57, 4096
  s_mov_b64 exec, s[94:95]
  buffer_load_dwordx4 a[176:179], v1, s[4:7], s57 offen offset:0
  s_mov_b64 exec, -1
  v_mul_f32 v140, v48, v56
  v_mul_f32 v141, v49, v57
  ds_read_b128 v[232:235], v3 offset:0
  v_mfma_f32_32x32x16_bf16 v[16:31], v[244:247], a[104:107], v[16:31]
  v_mul_f32 v142, v50, v58
  v_mul_f32 v143, v51, v59
  ds_read_b128 v[236:239], v3 offset:1024
  s_waitcnt lgkmcnt(3)
  v_mfma_f32_32x32x16_bf16 v[16:31], v[208:211], a[108:111], v[16:31]
  s_mov_b64 exec, s[94:95]
  buffer_load_dwordx4 a[180:183], v1, s[4:7], s57 offen offset:1024
  s_mov_b64 exec, -1
  v_mul_f32 v144, v52, v60
  v_mul_f32 v145, v53, v61
  ds_read_b128 v[240:243], v3 offset:2048
  v_mov_b32 v204, v80
  v_mov_b32 v205, v80
  v_mfma_f32_32x32x16_bf16 v[16:31], v[212:215], a[112:115], v[16:31]
  v_mul_f32 v146, v54, v62
  v_mul_f32 v147, v55, v63
  ds_read_b128 v[244:247], v3 offset:3072
  v_mfma_f32_32x32x16_bf16 v[16:31], v[216:219], a[116:119], v[16:31]
  s_mov_b64 exec, s[94:95]
  buffer_load_dwordx4 a[184:187], v1, s[4:7], s57 offen offset:2048
  s_mov_b64 exec, -1
  v_exp_f32 v148, v148
  v_exp_f32 v149, v149
  ds_read_b128 v[208:211], v3 offset:4096
  v_mfma_f32_32x32x16_bf16 v[16:31], v[220:223], a[120:123], v[16:31]
  v_exp_f32 v150, v150
  v_exp_f32 v151, v151
  ds_read_b128 v[212:215], v3 offset:5120
  s_waitcnt lgkmcnt(4)
  v_mfma_f32_32x32x16_bf16 v[16:31], v[224:227], a[124:127], v[16:31]
  s_mov_b64 exec, s[94:95]
  buffer_load_dwordx4 a[188:191], v1, s[4:7], s57 offen offset:3072
  s_mov_b64 exec, -1
  v_exp_f32 v152, v152
  v_exp_f32 v153, v153
  ds_read_b128 v[216:219], v3 offset:6144
  v_mfma_f32_32x32x16_bf16 v[16:31], v[204:207], v[108:111], v[16:31]
  v_exp_f32 v154, v154
  v_exp_f32 v155, v155
  ds_read_b128 v[220:223], v3 offset:7168
  v_mfma_f32_32x32x16_bf16 v[32:47], v[232:235], a[0:3], 0
  v_fma_f32 v148, v148, v106, v106
  v_fma_f32 v149, v149, v106, v106
  s_barrier
  ds_read_b128 v[224:227], v3 offset:8192
  v_mfma_f32_32x32x16_bf16 v[32:47], v[236:239], a[4:7], v[32:47]
  v_fma_f32 v150, v150, v106, v106
  v_fma_f32 v151, v151, v106, v106
  ds_read_b128 v[228:231], v3 offset:9216
  s_waitcnt lgkmcnt(4)
  v_mfma_f32_32x32x16_bf16 v[32:47], v[240:243], a[8:11], v[32:47]
  s_add_u32 s42, s20, s24
  s_add_u32 s43, s28, s24
  s_mov_b32 m0, s42
  s_nop 0
  buffer_load_dwordx4 v1, s[4:7], s43 offen offset:0 lds
  v_fma_f32 v152, v152, v106, v106
  v_fma_f32 v153, v153, v106, v106
  ds_read_b128 v[232:235], v3 offset:10240
  v_mfma_f32_32x32x16_bf16 v[32:47], v[244:247], a[12:15], v[32:47]
  v_fma_f32 v154, v154, v106, v106
  v_fma_f32 v155, v155, v106, v106
  ds_read_b128 v[236:239], v3 offset:11264
  v_mfma_f32_32x32x16_bf16 v[32:47], v[208:211], a[16:19], v[32:47]
  buffer_load_dwordx4 v1, s[4:7], s43 offen offset:1024 lds
  v_rcp_f32 v148, v148
  v_rcp_f32 v149, v149
  ds_read_b128 v[240:243], v3 offset:12288
  v_mfma_f32_32x32x16_bf16 v[32:47], v[212:215], a[20:23], v[32:47]
  v_rcp_f32 v150, v150
  v_rcp_f32 v151, v151
  ds_read_b128 v[244:247], v3 offset:13312
  s_waitcnt lgkmcnt(4)
  v_mfma_f32_32x32x16_bf16 v[32:47], v[216:219], a[24:27], v[32:47]
  buffer_load_dwordx4 v1, s[4:7], s43 offen offset:2048 lds
  v_rcp_f32 v152, v152
  v_rcp_f32 v153, v153
  ds_read_b128 v[208:211], v3 offset:14336
  v_mfma_f32_32x32x16_bf16 v[32:47], v[220:223], a[28:31], v[32:47]
  v_rcp_f32 v154, v154
  v_rcp_f32 v155, v155
  ds_read_b128 v[212:215], v3 offset:15360
  v_mfma_f32_32x32x16_bf16 v[32:47], v[224:227], a[32:35], v[32:47]
  buffer_load_dwordx4 v1, s[4:7], s43 offen offset:3072 lds
  s_add_u32 s51, s85, 2048
  v_mul_f32 v140, v140, v148
  ds_read_b128 v[216:219], v3 offset:16384
  v_mfma_f32_32x32x16_bf16 v[32:47], v[228:231], a[36:39], v[32:47]
  v_mul_f32 v141, v141, v149
  v_mul_f32 v142, v142, v150
  ds_read_b128 v[220:223], v3 offset:17408
  s_waitcnt lgkmcnt(4)
  v_mfma_f32_32x32x16_bf16 v[32:47], v[232:235], a[40:43], v[32:47]
  s_add_u32 m0, s42, 4096
  s_add_u32 s43, s43, 4096
  buffer_load_dwordx4 v1, s[4:7], s43 offen offset:0 lds
  v_mul_f32 v143, v143, v151
  v_mul_f32 v144, v144, v152
  ds_read_b128 v[224:227], v3 offset:18432
  v_mfma_f32_32x32x16_bf16 v[32:47], v[236:239], a[44:47], v[32:47]
  v_mul_f32 v145, v145, v153
  v_mul_f32 v146, v146, v154
  ds_read_b128 v[228:231], v3 offset:19456
  v_mfma_f32_32x32x16_bf16 v[32:47], v[240:243], a[48:51], v[32:47]
  buffer_load_dwordx4 v1, s[4:7], s43 offen offset:1024 lds
  v_mul_f32 v147, v147, v155
  v_cvt_pk_bf16_f32 v156, v140, v141
  ds_read_b128 v[232:235], v3 offset:20480
  v_mfma_f32_32x32x16_bf16 v[32:47], v[244:247], a[52:55], v[32:47]
  v_cvt_pk_bf16_f32 v157, v142, v143
  v_cvt_pk_bf16_f32 v158, v144, v145
  ds_read_b128 v[236:239], v3 offset:21504
  s_waitcnt lgkmcnt(4)
  v_mfma_f32_32x32x16_bf16 v[32:47], v[208:211], a[56:59], v[32:47]
  buffer_load_dwordx4 v1, s[4:7], s43 offen offset:2048 lds
  v_cvt_pk_bf16_f32 v159, v146, v147
  buffer_store_dwordx4 v[156:159], v1, s[4:7], s51 offen sc1
  ds_read_b128 v[240:243], v3 offset:22528
  v_mfma_f32_32x32x16_bf16 v[32:47], v[212:215], a[60:63], v[32:47]
  v_mul_f32 v148, v16, v105
  ds_read_b128 v[244:247], v3 offset:23552
  v_mfma_f32_32x32x16_bf16 v[32:47], v[216:219], a[64:67], v[32:47]
  buffer_load_dwordx4 v1, s[4:7], s43 offen offset:3072 lds
  v_mul_f32 v149, v17, v105
  v_mul_f32 v150, v18, v105
  ds_read_b128 v[208:211], v3 offset:24576
  v_mfma_f32_32x32x16_bf16 v[32:47], v[220:223], a[68:71], v[32:47]
  v_mul_f32 v151, v19, v105
  v_mul_f32 v152, v20, v105
  ds_read_b128 v[212:215], v3 offset:25600
  s_waitcnt lgkmcnt(4)
  v_mfma_f32_32x32x16_bf16 v[32:47], v[224:227], a[72:75], v[32:47]
  s_add_u32 s57, s28, s24
  s_add_u32 s57, s57, 163840
  s_mov_b64 exec, s[94:95]
  buffer_load_dwordx4 a[192:195], v1, s[4:7], s57 offen offset:0
  s_mov_b64 exec, -1
  v_mul_f32 v153, v21, v105
  v_mul_f32 v154, v22, v105
  ds_read_b128 v[216:219], v3 offset:26624
  v_mfma_f32_32x32x16_bf16 v[32:47], v[228:231], a[76:79], v[32:47]
  v_mul_f32 v155, v23, v105
  v_mul_f32 v140, v16, v24
  ds_read_b128 v[220:223], v3 offset:27648
  v_mfma_f32_32x32x16_bf16 v[32:47], v[232:235], a[80:83], v[32:47]
  s_mov_b64 exec, s[94:95]
  buffer_load_dwordx4 a[196:199], v1, s[4:7], s57 offen offset:1024
  s_mov_b64 exec, -1
  v_mul_f32 v141, v17, v25
  v_mul_f32 v142, v18, v26
  ds_read_b128 v[224:227], v3 offset:28672
  v_mfma_f32_32x32x16_bf16 v[32:47], v[236:239], a[84:87], v[32:47]
  v_mul_f32 v143, v19, v27
  v_mul_f32 v144, v20, v28
  ds_read_b128 v[228:231], v3 offset:29696
  s_waitcnt lgkmcnt(4)
  v_mfma_f32_32x32x16_bf16 v[32:47], v[240:243], a[88:91], v[32:47]
  s_mov_b64 exec, s[94:95]
  buffer_load_dwordx4 a[200:203], v1, s[4:7], s57 offen offset:2048
  s_mov_b64 exec, -1
  v_mul_f32 v145, v21, v29
  v_mul_f32 v146, v22, v30
  ds_read_b128 v[232:235], v3 offset:30720
  v_mfma_f32_32x32x16_bf16 v[32:47], v[244:247], a[92:95], v[32:47]
  v_mul_f32 v147, v23, v31
  v_exp_f32 v148, v148
  ds_read_b128 v[236:239], v3 offset:31744
  v_mfma_f32_32x32x16_bf16 v[32:47], v[208:211], a[96:99], v[32:47]
  s_mov_b64 exec, s[94:95]
  buffer_load_dwordx4 a[204:207], v1, s[4:7], s57 offen offset:3072
  s_mov_b64 exec, -1
  v_exp_f32 v149, v149
  v_exp_f32 v150, v150
  s_waitcnt vmcnt(30)
  s_barrier
  v_mfma_f32_32x32x16_bf16 v[32:47], v[212:215], a[100:103], v[32:47]
  v_exp_f32 v151, v151
  v_exp_f32 v152, v152
  ds_read_b128 v[244:247], v4 offset:0
  s_waitcnt lgkmcnt(3)
  v_mfma_f32_32x32x16_bf16 v[32:47], v[216:219], a[104:107], v[32:47]
  s_add_u32 s57, s57, 4096
  s_mov_b64 exec, s[94:95]
  buffer_load_dwordx4 a[208:211], v1, s[4:7], s57 offen offset:0
  s_mov_b64 exec, -1
  v_exp_f32 v153, v153
  v_exp_f32 v154, v154
  ds_read_b128 v[208:211], v4 offset:1024
  v_mfma_f32_32x32x16_bf16 v[32:47], v[220:223], a[108:111], v[32:47]
  v_exp_f32 v155, v155
  v_fma_f32 v148, v148, v106, v106
  ds_read_b128 v[212:215], v4 offset:2048
  v_mov_b32 v84, v81
  v_mov_b32 v85, v81
  v_mfma_f32_32x32x16_bf16 v[32:47], v[224:227], a[112:115], v[32:47]
  s_mov_b64 exec, s[94:95]
  buffer_load_dwordx4 a[212:215], v1, s[4:7], s57 offen offset:1024
  s_mov_b64 exec, -1
  v_fma_f32 v149, v149, v106, v106
  v_fma_f32 v150, v150, v106, v106
  ds_read_b128 v[216:219], v4 offset:3072
  v_mfma_f32_32x32x16_bf16 v[32:47], v[228:231], a[116:119], v[32:47]
  v_fma_f32 v151, v151, v106, v106
  v_fma_f32 v152, v152, v106, v106
  ds_read_b128 v[220:223], v4 offset:4096
  s_waitcnt lgkmcnt(4)
  v_mfma_f32_32x32x16_bf16 v[32:47], v[232:235], a[120:123], v[32:47]
  s_mov_b64 exec, s[94:95]
  buffer_load_dwordx4 a[216:219], v1, s[4:7], s57 offen offset:2048
  s_mov_b64 exec, -1
  v_fma_f32 v153, v153, v106, v106
  v_fma_f32 v154, v154, v106, v106
  ds_read_b128 v[224:227], v4 offset:5120
  v_mfma_f32_32x32x16_bf16 v[32:47], v[236:239], a[124:127], v[32:47]
  v_fma_f32 v155, v155, v106, v106
  v_rcp_f32 v148, v148
  ds_read_b128 v[228:231], v4 offset:6144
  v_mfma_f32_32x32x16_bf16 v[32:47], v[84:87], v[108:111], v[32:47]
  s_mov_b64 exec, s[94:95]
  buffer_load_dwordx4 a[220:223], v1, s[4:7], s57 offen offset:3072
  s_mov_b64 exec, -1
  v_rcp_f32 v149, v149
  v_rcp_f32 v150, v150
  ds_read_b128 v[232:235], v4 offset:7168
  v_mfma_f32_32x32x16_bf16 v[48:63], v[244:247], a[0:3], 0
  v_rcp_f32 v151, v151
  v_rcp_f32 v152, v152
  s_barrier
  ds_read_b128 v[236:239], v4 offset:8192
  s_waitcnt lgkmcnt(4)
  v_mfma_f32_32x32x16_bf16 v[48:63], v[208:211], a[4:7], v[48:63]
  s_add_u32 s42, s21, s24
  s_add_u32 s43, s28, s24
  s_add_u32 s43, s43, 32768
  s_mov_b32 m0, s42
  s_nop 0
  buffer_load_dwordx4 v1, s[4:7], s43 offen offset:0 lds
  v_rcp_f32 v153, v153
  v_rcp_f32 v154, v154
  ds_read_b128 v[240:243], v4 offset:9216
  v_mfma_f32_32x32x16_bf16 v[48:63], v[212:215], a[8:11], v[48:63]
  v_rcp_f32 v155, v155
  s_add_u32 s51, s85, 3072
  ds_read_b128 v[244:247], v4 offset:10240
  v_mfma_f32_32x32x16_bf16 v[48:63], v[216:219], a[12:15], v[48:63]
  buffer_load_dwordx4 v1, s[4:7], s43 offen offset:1024 lds
  v_mul_f32 v140, v140, v148
  v_mul_f32 v141, v141, v149
  ds_read_b128 v[208:211], v4 offset:11264
  v_mfma_f32_32x32x16_bf16 v[48:63], v[220:223], a[16:19], v[48:63]
  v_mul_f32 v142, v142, v150
  v_mul_f32 v143, v143, v151
  ds_read_b128 v[212:215], v4 offset:12288
  s_waitcnt lgkmcnt(4)
  v_mfma_f32_32x32x16_bf16 v[48:63], v[224:227], a[20:23], v[48:63]
  buffer_load_dwordx4 v1, s[4:7], s43 offen offset:2048 lds
  v_mul_f32 v144, v144, v152
  v_mul_f32 v145, v145, v153
  ds_read_b128 v[216:219], v4 offset:13312
  v_mfma_f32_32x32x16_bf16 v[48:63], v[228:231], a[24:27], v[48:63]
  v_mul_f32 v146, v146, v154
  v_mul_f32 v147, v147, v155
  ds_read_b128 v[220:223], v4 offset:14336
  v_mfma_f32_32x32x16_bf16 v[48:63], v[232:235], a[28:31], v[48:63]
  buffer_load_dwordx4 v1, s[4:7], s43 offen offset:3072 lds
  v_cvt_pk_bf16_f32 v156, v140, v141
  v_cvt_pk_bf16_f32 v157, v142, v143
  ds_read_b128 v[224:227], v4 offset:15360
  v_mfma_f32_32x32x16_bf16 v[48:63], v[236:239], a[32:35], v[48:63]
  v_cvt_pk_bf16_f32 v158, v144, v145
  v_cvt_pk_bf16_f32 v159, v146, v147
  ds_read_b128 v[228:231], v4 offset:16384
  s_waitcnt lgkmcnt(4)
  v_mfma_f32_32x32x16_bf16 v[48:63], v[240:243], a[36:39], v[48:63]
  s_add_u32 m0, s42, 4096
  s_add_u32 s43, s43, 4096
  buffer_load_dwordx4 v1, s[4:7], s43 offen offset:0 lds
  buffer_store_dwordx4 v[156:159], v1, s[4:7], s51 offen sc1
  v_mul_f32 v148, v32, v105
  ds_read_b128 v[232:235], v4 offset:17408
  v_mfma_f32_32x32x16_bf16 v[48:63], v[244:247], a[40:43], v[48:63]
  v_mul_f32 v149, v33, v105
  v_mul_f32 v150, v34, v105
  ds_read_b128 v[236:239], v4 offset:18432
  v_mfma_f32_32x32x16_bf16 v[48:63], v[208:211], a[44:47], v[48:63]
  buffer_load_dwordx4 v1, s[4:7], s43 offen offset:1024 lds
  v_mul_f32 v151, v35, v105
  v_mul_f32 v152, v36, v105
  ds_read_b128 v[240:243], v4 offset:19456
  v_mfma_f32_32x32x16_bf16 v[48:63], v[212:215], a[48:51], v[48:63]
  v_mul_f32 v153, v37, v105
  v_mul_f32 v154, v38, v105
  ds_read_b128 v[244:247], v4 offset:20480
  s_waitcnt lgkmcnt(4)
  v_mfma_f32_32x32x16_bf16 v[48:63], v[216:219], a[52:55], v[48:63]
  buffer_load_dwordx4 v1, s[4:7], s43 offen offset:2048 lds
  v_mul_f32 v155, v39, v105
  v_mul_f32 v140, v32, v40
  ds_read_b128 v[208:211], v4 offset:21504
  v_mfma_f32_32x32x16_bf16 v[48:63], v[220:223], a[56:59], v[48:63]
  v_mul_f32 v141, v33, v41
  v_mul_f32 v142, v34, v42
  ds_read_b128 v[212:215], v4 offset:22528
  v_mfma_f32_32x32x16_bf16 v[48:63], v[224:227], a[60:63], v[48:63]
  buffer_load_dwordx4 v1, s[4:7], s43 offen offset:3072 lds
  v_mul_f32 v143, v35, v43
  v_mul_f32 v144, v36, v44
  ds_read_b128 v[216:219], v4 offset:23552
  v_mfma_f32_32x32x16_bf16 v[48:63], v[228:231], a[64:67], v[48:63]
  v_mul_f32 v145, v37, v45
  v_mul_f32 v146, v38, v46
  ds_read_b128 v[220:223], v4 offset:24576
  s_waitcnt lgkmcnt(4)
  v_mfma_f32_32x32x16_bf16 v[48:63], v[232:235], a[68:71], v[48:63]
  s_add_u32 s57, s28, s24
  s_add_u32 s57, s57, 196608
  s_mov_b64 exec, s[94:95]
  buffer_load_dwordx4 a[224:227], v1, s[4:7], s57 offen offset:0
  s_mov_b64 exec, -1
  v_mul_f32 v147, v39, v47
  v_exp_f32 v148, v148
  ds_read_b128 v[224:227], v4 offset:25600
  v_mfma_f32_32x32x16_bf16 v[48:63], v[236:239], a[72:75], v[48:63]
  v_exp_f32 v149, v149
  v_exp_f32 v150, v150
  ds_read_b128 v[228:231], v4 offset:26624
  v_mfma_f32_32x32x16_bf16 v[48:63], v[240:243], a[76:79], v[48:63]
  s_mov_b64 exec, s[94:95]
  buffer_load_dwordx4 a[228:231], v1, s[4:7], s57 offen offset:1024
  s_mov_b64 exec, -1
  v_exp_f32 v151, v151
  v_exp_f32 v152, v152
  ds_read_b128 v[232:235], v4 offset:27648
  v_mfma_f32_32x32x16_bf16 v[48:63], v[244:247], a[80:83], v[48:63]
  v_exp_f32 v153, v153
  v_exp_f32 v154, v154
  ds_read_b128 v[236:239], v4 offset:28672
  s_waitcnt lgkmcnt(4)
  v_mfma_f32_32x32x16_bf16 v[48:63], v[208:211], a[84:87], v[48:63]
  s_mov_b64 exec, s[94:95]
  buffer_load_dwordx4 a[232:235], v1, s[4:7], s57 offen offset:2048
  s_mov_b64 exec, -1
  v_exp_f32 v155, v155
  v_fma_f32 v148, v148, v106, v106
  ds_read_b128 v[240:243], v4 offset:29696
  v_mfma_f32_32x32x16_bf16 v[48:63], v[212:215], a[88:91], v[48:63]
  v_fma_f32 v149, v149, v106, v106
  v_fma_f32 v150, v150, v106, v106
  ds_read_b128 v[244:247], v4 offset:30720
  v_mfma_f32_32x32x16_bf16 v[48:63], v[216:219], a[92:95], v[48:63]
  s_mov_b64 exec, s[94:95]
  buffer_load_dwordx4 a[236:239], v1, s[4:7], s57 offen offset:3072
  s_mov_b64 exec, -1
  v_fma_f32 v151, v151, v106, v106
  v_fma_f32 v152, v152, v106, v106
  ds_read_b128 v[208:211], v4 offset:31744
  v_mfma_f32_32x32x16_bf16 v[48:63], v[220:223], a[96:99], v[48:63]
  v_fma_f32 v153, v153, v106, v106
  v_fma_f32 v154, v154, v106, v106
  s_waitcnt vmcnt(39)
  s_barrier
  s_waitcnt lgkmcnt(3)
  v_mfma_f32_32x32x16_bf16 v[48:63], v[224:227], a[100:103], v[48:63]
  s_add_u32 s57, s57, 4096
  s_mov_b64 exec, s[94:95]
  buffer_load_dwordx4 a[240:243], v1, s[4:7], s57 offen offset:0
  s_mov_b64 exec, -1
  v_fma_f32 v155, v155, v106, v106
  v_rcp_f32 v148, v148
  ds_read_b128 v[216:219], v5 offset:0
  v_mfma_f32_32x32x16_bf16 v[48:63], v[228:231], a[104:107], v[48:63]
  v_rcp_f32 v149, v149
  v_rcp_f32 v150, v150
  ds_read_b128 v[220:223], v5 offset:1024
  v_mfma_f32_32x32x16_bf16 v[48:63], v[232:235], a[108:111], v[48:63]
  s_mov_b64 exec, s[94:95]
  buffer_load_dwordx4 a[244:247], v1, s[4:7], s57 offen offset:1024
  s_mov_b64 exec, -1
  v_rcp_f32 v151, v151
  v_rcp_f32 v152, v152
  ds_read_b128 v[224:227], v5 offset:2048
  v_mov_b32 v204, v82
  v_mov_b32 v205, v82
  v_mfma_f32_32x32x16_bf16 v[48:63], v[236:239], a[112:115], v[48:63]
  v_rcp_f32 v153, v153
  v_rcp_f32 v154, v154
  ds_read_b128 v[228:231], v5 offset:3072
  s_waitcnt lgkmcnt(4)
  v_mfma_f32_32x32x16_bf16 v[48:63], v[240:243], a[116:119], v[48:63]
  s_mov_b64 exec, s[94:95]
  buffer_load_dwordx4 a[248:251], v1, s[4:7], s57 offen offset:2048
  s_mov_b64 exec, -1
  v_rcp_f32 v155, v155
  s_add_u32 s51, s85, 4096
  ds_read_b128 v[232:235], v5 offset:4096
  v_mfma_f32_32x32x16_bf16 v[48:63], v[244:247], a[120:123], v[48:63]
  v_mul_f32 v140, v140, v148
  v_mul_f32 v141, v141, v149
  ds_read_b128 v[236:239], v5 offset:5120
  v_mfma_f32_32x32x16_bf16 v[48:63], v[208:211], a[124:127], v[48:63]
  s_mov_b64 exec, s[94:95]
  buffer_load_dwordx4 a[252:255], v1, s[4:7], s57 offen offset:3072
  s_mov_b64 exec, -1
  v_mul_f32 v142, v142, v150
  v_mul_f32 v143, v143, v151
  ds_read_b128 v[240:243], v5 offset:6144
  v_mfma_f32_32x32x16_bf16 v[48:63], v[204:207], v[108:111], v[48:63]
  v_mul_f32 v144, v144, v152
  v_mul_f32 v145, v145, v153
  ds_read_b128 v[244:247], v5 offset:7168
  s_waitcnt lgkmcnt(4)
  v_mfma_f32_32x32x16_bf16 v[16:31], v[216:219], a[0:3], 0
  v_mul_f32 v146, v146, v154
  v_mul_f32 v147, v147, v155
  s_barrier
  ds_read_b128 v[208:211], v5 offset:8192
  v_mfma_f32_32x32x16_bf16 v[16:31], v[220:223], a[4:7], v[16:31]
  v_cvt_pk_bf16_f32 v156, v140, v141
  v_cvt_pk_bf16_f32 v157, v142, v143
  ds_read_b128 v[212:215], v5 offset:9216
  v_mfma_f32_32x32x16_bf16 v[16:31], v[224:227], a[8:11], v[16:31]
  s_add_u32 s42, s22, s24
  s_add_u32 s43, s28, s24
  s_add_u32 s43, s43, 65536
  s_mov_b32 m0, s42
  s_nop 0
  buffer_load_dwordx4 v1, s[4:7], s43 offen offset:0 lds
  v_cvt_pk_bf16_f32 v158, v144, v145
  v_cvt_pk_bf16_f32 v159, v146, v147
  ds_read_b128 v[216:219], v5 offset:10240
  v_mfma_f32_32x32x16_bf16 v[16:31], v[228:231], a[12:15], v[16:31]
  buffer_store_dwordx4 v[156:159], v1, s[4:7], s51 offen sc1
  v_mul_f32 v148, v48, v105
  ds_read_b128 v[220:223], v5 offset:11264
  s_waitcnt lgkmcnt(4)
  v_mfma_f32_32x32x16_bf16 v[16:31], v[232:235], a[16:19], v[16:31]
  buffer_load_dwordx4 v1, s[4:7], s43 offen offset:1024 lds
  v_mul_f32 v149, v49, v105
  v_mul_f32 v150, v50, v105
  ds_read_b128 v[224:227], v5 offset:12288
  v_mfma_f32_32x32x16_bf16 v[16:31], v[236:239], a[20:23], v[16:31]
  v_mul_f32 v151, v51, v105
  v_mul_f32 v152, v52, v105
  ds_read_b128 v[228:231], v5 offset:13312
  v_mfma_f32_32x32x16_bf16 v[16:31], v[240:243], a[24:27], v[16:31]
  buffer_load_dwordx4 v1, s[4:7], s43 offen offset:2048 lds
  v_mul_f32 v153, v53, v105
  v_mul_f32 v154, v54, v105
  ds_read_b128 v[232:235], v5 offset:14336
  v_mfma_f32_32x32x16_bf16 v[16:31], v[244:247], a[28:31], v[16:31]
  v_mul_f32 v155, v55, v105
  v_mul_f32 v140, v48, v56
  ds_read_b128 v[236:239], v5 offset:15360
  s_waitcnt lgkmcnt(4)
  v_mfma_f32_32x32x16_bf16 v[16:31], v[208:211], a[32:35], v[16:31]
  buffer_load_dwordx4 v1, s[4:7], s43 offen offset:3072 lds
  v_mul_f32 v141, v49, v57
  v_mul_f32 v142, v50, v58
  ds_read_b128 v[240:243], v5 offset:16384
  v_mfma_f32_32x32x16_bf16 v[16:31], v[212:215], a[36:39], v[16:31]
  v_mul_f32 v143, v51, v59
  v_mul_f32 v144, v52, v60
  ds_read_b128 v[244:247], v5 offset:17408
  v_mfma_f32_32x32x16_bf16 v[16:31], v[216:219], a[40:43], v[16:31]
  s_add_u32 m0, s42, 4096
  s_add_u32 s43, s43, 4096
  buffer_load_dwordx4 v1, s[4:7], s43 offen offset:0 lds
  v_mul_f32 v145, v53, v61
  v_mul_f32 v146, v54, v62
  ds_read_b128 v[208:211], v5 offset:18432
  v_mfma_f32_32x32x16_bf16 v[16:31], v[220:223], a[44:47], v[16:31]
  v_mul_f32 v147, v55, v63
  v_exp_f32 v148, v148
  ds_read_b128 v[212:215], v5 offset:19456
  s_waitcnt lgkmcnt(4)
  v_mfma_f32_32x32x16_bf16 v[16:31], v[224:227], a[48:51], v[16:31]
  buffer_load_dwordx4 v1, s[4:7], s43 offen offset:1024 lds
  v_exp_f32 v149, v149
  v_exp_f32 v150, v150
  ds_read_b128 v[216:219], v5 offset:20480
  v_mfma_f32_32x32x16_bf16 v[16:31], v[228:231], a[52:55], v[16:31]
  v_exp_f32 v151, v151
  v_exp_f32 v152, v152
  ds_read_b128 v[220:223], v5 offset:21504
  v_mfma_f32_32x32x16_bf16 v[16:31], v[232:235], a[56:59], v[16:31]
  buffer_load_dwordx4 v1, s[4:7], s43 offen offset:2048 lds
  v_exp_f32 v153, v153
  v_exp_f32 v154, v154
  ds_read_b128 v[224:227], v5 offset:22528
  v_mfma_f32_32x32x16_bf16 v[16:31], v[236:239], a[60:63], v[16:31]
  v_exp_f32 v155, v155
  v_fma_f32 v148, v148, v106, v106
  ds_read_b128 v[228:231], v5 offset:23552
  s_waitcnt lgkmcnt(4)
  v_mfma_f32_32x32x16_bf16 v[16:31], v[240:243], a[64:67], v[16:31]
  buffer_load_dwordx4 v1, s[4:7], s43 offen offset:3072 lds
  v_fma_f32 v149, v149, v106, v106
  v_fma_f32 v150, v150, v106, v106
  ds_read_b128 v[232:235], v5 offset:24576
  v_mfma_f32_32x32x16_bf16 v[16:31], v[244:247], a[68:71], v[16:31]
  v_fma_f32 v151, v151, v106, v106
  v_fma_f32 v152, v152, v106, v106
  ds_read_b128 v[236:239], v5 offset:25600
  v_mfma_f32_32x32x16_bf16 v[16:31], v[208:211], a[72:75], v[16:31]
  v_fma_f32 v153, v153, v106, v106
  v_fma_f32 v154, v154, v106, v106
  ds_read_b128 v[240:243], v5 offset:26624
  v_mfma_f32_32x32x16_bf16 v[16:31], v[212:215], a[76:79], v[16:31]
  v_fma_f32 v155, v155, v106, v106
  v_rcp_f32 v148, v148
  ds_read_b128 v[244:247], v5 offset:27648
  s_waitcnt lgkmcnt(4)
  v_mfma_f32_32x32x16_bf16 v[16:31], v[216:219], a[80:83], v[16:31]
  v_rcp_f32 v149, v149
  v_rcp_f32 v150, v150
  ds_read_b128 v[208:211], v5 offset:28672
  v_mfma_f32_32x32x16_bf16 v[16:31], v[220:223], a[84:87], v[16:31]
  v_rcp_f32 v151, v151
  v_rcp_f32 v152, v152
  ds_read_b128 v[212:215], v5 offset:29696
  v_mfma_f32_32x32x16_bf16 v[16:31], v[224:227], a[88:91], v[16:31]
  v_rcp_f32 v153, v153
  v_rcp_f32 v154, v154
  ds_read_b128 v[216:219], v5 offset:30720
  v_mfma_f32_32x32x16_bf16 v[16:31], v[228:231], a[92:95], v[16:31]
  v_rcp_f32 v155, v155
  s_add_u32 s51, s85, 5120
  ds_read_b128 v[220:223], v5 offset:31744
  s_waitcnt lgkmcnt(4)
  v_mfma_f32_32x32x16_bf16 v[16:31], v[232:235], a[96:99], v[16:31]
  v_mul_f32 v140, v140, v148
  v_mul_f32 v141, v141, v149
  v_mfma_f32_32x32x16_bf16 v[16:31], v[236:239], a[100:103], v[16:31]
  v_mul_f32 v142, v142, v150
  v_mul_f32 v143, v143, v151
  v_mfma_f32_32x32x16_bf16 v[16:31], v[240:243], a[104:107], v[16:31]
  v_mul_f32 v144, v144, v152
  v_mul_f32 v145, v145, v153
  v_mfma_f32_32x32x16_bf16 v[16:31], v[244:247], a[108:111], v[16:31]
  v_mul_f32 v146, v146, v154
  v_mul_f32 v147, v147, v155
  s_waitcnt lgkmcnt(0)
  v_mov_b32 v84, v83
  v_mov_b32 v85, v83
  v_mfma_f32_32x32x16_bf16 v[16:31], v[208:211], a[112:115], v[16:31]
  v_cvt_pk_bf16_f32 v156, v140, v141
  v_cvt_pk_bf16_f32 v157, v142, v143
  v_mfma_f32_32x32x16_bf16 v[16:31], v[212:215], a[116:119], v[16:31]
  v_cvt_pk_bf16_f32 v158, v144, v145
  v_cvt_pk_bf16_f32 v159, v146, v147
  v_mfma_f32_32x32x16_bf16 v[16:31], v[216:219], a[120:123], v[16:31]
  buffer_store_dwordx4 v[156:159], v1, s[4:7], s51 offen sc1
  v_mfma_f32_32x32x16_bf16 v[16:31], v[220:223], a[124:127], v[16:31]
  v_mfma_f32_32x32x16_bf16 v[16:31], v[84:87], v[108:111], v[16:31]
  s_nop 11
  v_mul_f32 v148, v16, v105
  v_mul_f32 v149, v17, v105
  v_mul_f32 v150, v18, v105
  v_mul_f32 v151, v19, v105
  v_mul_f32 v152, v20, v105
  v_mul_f32 v153, v21, v105
  v_mul_f32 v154, v22, v105
  v_mul_f32 v155, v23, v105
  v_mul_f32 v140, v16, v24
  v_mul_f32 v141, v17, v25
  v_mul_f32 v142, v18, v26
  v_mul_f32 v143, v19, v27
  v_mul_f32 v144, v20, v28
  v_mul_f32 v145, v21, v29
  v_mul_f32 v146, v22, v30
  v_mul_f32 v147, v23, v31
  v_exp_f32 v148, v148
  v_exp_f32 v149, v149
  v_exp_f32 v150, v150
  v_exp_f32 v151, v151
  v_exp_f32 v152, v152
  v_exp_f32 v153, v153
  v_exp_f32 v154, v154
  v_exp_f32 v155, v155
  v_fma_f32 v148, v148, v106, v106
  v_fma_f32 v149, v149, v106, v106
  v_fma_f32 v150, v150, v106, v106
  v_fma_f32 v151, v151, v106, v106
  v_fma_f32 v152, v152, v106, v106
  v_fma_f32 v153, v153, v106, v106
  v_fma_f32 v154, v154, v106, v106
  v_fma_f32 v155, v155, v106, v106
  v_rcp_f32 v148, v148
  v_rcp_f32 v149, v149
  v_rcp_f32 v150, v150
  v_rcp_f32 v151, v151
  v_rcp_f32 v152, v152
  v_rcp_f32 v153, v153
  v_rcp_f32 v154, v154
  v_rcp_f32 v155, v155
  s_add_u32 s51, s85, 6144
  v_mul_f32 v140, v140, v148
  v_mul_f32 v141, v141, v149
  v_mul_f32 v142, v142, v150
  v_mul_f32 v143, v143, v151
  v_mul_f32 v144, v144, v152
  v_mul_f32 v145, v145, v153
  v_mul_f32 v146, v146, v154
  v_mul_f32 v147, v147, v155
  v_cvt_pk_bf16_f32 v156, v140, v141
  v_cvt_pk_bf16_f32 v157, v142, v143
  v_cvt_pk_bf16_f32 v158, v144, v145
  v_cvt_pk_bf16_f32 v159, v146, v147
  buffer_store_dwordx4 v[156:159], v1, s[4:7], s51 offen sc1
  s_waitcnt vmcnt(0)
  s_barrier
  s_add_u32 s17, s17, 1
  s_cmp_lg_u32 s12, 0
  s_cbranch_scc1 hop___prompt_38
  s_lshl_b32 s45, s14, 2
  s_add_u32 s45, s45, s37
  v_mov_b32 v10, s17
  v_mov_b32 v11, 0
  s_mov_b64 exec, 1
  s_cmp_lg_u32 s16, 0
  s_cbranch_scc1 fs___prompt_39
  buffer_store_dword v10, v11, s[4:7], s45 offen
  s_branch fd___prompt_40
fs___prompt_39:
  buffer_store_dword v10, v11, s[4:7], s45 offen sc1
fd___prompt_40:
  s_mov_b64 exec, -1
  s_mov_b32 s46, 0
poll___prompt_41:
  s_add_u32 s46, s46, 1
  s_cmp_gt_u32 s46, 4194304
  s_cbranch_scc1 pollt___prompt_43
  buffer_load_dword v9, v8, s[4:7], s37 offen sc1
  s_waitcnt vmcnt(0)
  v_subrev_u32 v10, s17, v9
  v_cmp_le_u32 vcc, 8, v10
  s_cbranch_vccz pollx___prompt_42
  s_branch poll___prompt_41
pollt___prompt_43:
  s_mov_b32 s18, 1
pollx___prompt_42:
hop___prompt_38:
  s_barrier
  s_lshl_b32 s44, s13, 2
  s_add_u32 s44, s44, s36
  s_mul_i32 s44, s44, 114688
  s_mul_i32 s45, s33, 57344
  s_add_u32 s44, s44, s45
  s_add_u32 s44, s44, 25165824
  v_add_u32 v132, s53, v2
  v_add_u32 v133, s54, v2
  buffer_load_dwordx4 a[0:3], v1, s[4:7], s44 offen offset:0 sc1
  buffer_load_dwordx4 a[4:7], v1, s[4:7], s44 offen offset:1024 sc1
  ds_read_b128 v[208:211], v132 offset:0
  ds_read_b128 v[212:215], v133 offset:0
  ds_read_b128 v[216:219], v132 offset:4096
  ds_read_b128 v[220:223], v133 offset:4096
  buffer_load_dwordx4 a[8:11], v1, s[4:7], s44 offen offset:2048 sc1
  buffer_load_dwordx4 a[12:15], v1, s[4:7], s44 offen offset:3072 sc1
  s_add_u32 s44, s44, 4096
  buffer_load_dwordx4 a[16:19], v1, s[4:7], s44 offen offset:0 sc1
  buffer_load_dwordx4 a[20:23], v1, s[4:7], s44 offen offset:1024 sc1
  buffer_load_dwordx4 a[24:27], v1, s[4:7], s44 offen offset:2048 sc1
  buffer_load_dwordx4 a[28:31], v1, s[4:7], s44 offen offset:3072 sc1
  s_add_u32 s44, s44, 4096
  buffer_load_dwordx4 a[32:35], v1, s[4:7], s44 offen offset:0 sc1
  buffer_load_dwordx4 a[36:39], v1, s[4:7], s44 offen offset:1024 sc1
  v_add_u32 v134, s53, v3
  v_add_u32 v135, s54, v3
  s_waitcnt vmcnt(9) lgkmcnt(2)
  v_mfma_f32_32x32x16_bf16 v[16:31], v[208:211], a[0:3], 0
  ds_read_b128 v[224:227], v132 offset:8192
  v_add_u32 v136, s24, v5
  ds_write_b128 v136, a[128:131] offset:0
  v_mfma_f32_32x32x16_bf16 v[32:47], v[212:215], a[0:3], 0
  ds_read_b128 v[228:231], v133 offset:8192
  buffer_load_dwordx4 a[40:43], v1, s[4:7], s44 offen offset:2048 sc1
  s_waitcnt vmcnt(9) lgkmcnt(3)
  v_mfma_f32_32x32x16_bf16 v[16:31], v[216:219], a[4:7], v[16:31]
  ds_read_b128 v[208:211], v132 offset:12288
  ds_write_b128 v136, a[132:135] offset:1024
  v_mfma_f32_32x32x16_bf16 v[32:47], v[220:223], a[4:7], v[32:47]
  ds_read_b128 v[212:215], v133 offset:12288
  buffer_load_dwordx4 a[44:47], v1, s[4:7], s44 offen offset:3072 sc1
  s_waitcnt vmcnt(9) lgkmcnt(3)
  v_mfma_f32_32x32x16_bf16 v[16:31], v[224:227], a[8:11], v[16:31]
  ds_read_b128 v[216:219], v132 offset:16384
  ds_write_b128 v136, a[136:139] offset:2048
  v_mfma_f32_32x32x16_bf16 v[32:47], v[228:231], a[8:11], v[32:47]
  ds_read_b128 v[220:223], v133 offset:16384
  s_add_u32 s44, s44, 4096
  buffer_load_dwordx4 a[48:51], v1, s[4:7], s44 offen offset:0 sc1
  s_waitcnt vmcnt(9) lgkmcnt(3)
  v_mfma_f32_32x32x16_bf16 v[16:31], v[208:211], a[12:15], v[16:31]
  ds_read_b128 v[224:227], v132 offset:20480
  ds_write_b128 v136, a[140:143] offset:3072
  v_mfma_f32_32x32x16_bf16 v[32:47], v[212:215], a[12:15], v[32:47]
  ds_read_b128 v[228:231], v133 offset:20480
  buffer_load_dwordx4 a[52:55], v1, s[4:7], s44 offen offset:1024 sc1
  s_waitcnt vmcnt(9) lgkmcnt(3)
  v_mfma_f32_32x32x16_bf16 v[16:31], v[216:219], a[16:19], v[16:31]
  ds_read_b128 v[208:211], v132 offset:24576
  ds_write_b128 v136, a[144:147] offset:4096
  v_mfma_f32_32x32x16_bf16 v[32:47], v[220:223], a[16:19], v[32:47]
  ds_read_b128 v[212:215], v133 offset:24576
  buffer_load_dwordx4 a[56:59], v1, s[4:7], s44 offen offset:2048 sc1
  s_waitcnt vmcnt(9) lgkmcnt(3)
  v_mfma_f32_32x32x16_bf16 v[16:31], v[224:227], a[20:23], v[16:31]
  ds_read_b128 v[216:219], v132 offset:28672
  ds_write_b128 v136, a[148:151] offset:5120
  v_mfma_f32_32x32x16_bf16 v[32:47], v[228:231], a[20:23], v[32:47]
  ds_read_b128 v[220:223], v133 offset:28672
  buffer_load_dwordx4 a[60:63], v1, s[4:7], s44 offen offset:3072 sc1
  s_barrier
  s_waitcnt vmcnt(9) lgkmcnt(3)
  v_mfma_f32_32x32x16_bf16 v[16:31], v[208:211], a[24:27], v[16:31]
  ds_read_b128 v[224:227], v134 offset:0
  ds_write_b128 v136, a[152:155] offset:6144
  v_mfma_f32_32x32x16_bf16 v[32:47], v[212:215], a[24:27], v[32:47]
  ds_read_b128 v[228:231], v135 offset:0
  s_add_u32 s44, s44, 4096
  buffer_load_dwordx4 a[64:67], v1, s[4:7], s44 offen offset:0 sc1
  s_waitcnt vmcnt(9) lgkmcnt(3)
  v_mfma_f32_32x32x16_bf16 v[16:31], v[216:219], a[28:31], v[16:31]
  ds_read_b128 v[208:211], v134 offset:4096
  ds_write_b128 v136, a[156:159] offset:7168
  v_mfma_f32_32x32x16_bf16 v[32:47], v[220:223], a[28:31], v[32:47]
  ds_read_b128 v[212:215], v135 offset:4096
  buffer_load_dwordx4 a[68:71], v1, s[4:7], s44 offen offset:1024 sc1
  v_add_u32 v132, s53, v4
  v_add_u32 v133, s54, v4
  s_waitcnt vmcnt(9) lgkmcnt(3)
  v_mfma_f32_32x32x16_bf16 v[16:31], v[224:227], a[32:35], v[16:31]
  ds_read_b128 v[216:219], v134 offset:8192
  v_mfma_f32_32x32x16_bf16 v[32:47], v[228:231], a[32:35], v[32:47]
  ds_read_b128 v[220:223], v135 offset:8192
  buffer_load_dwordx4 a[72:75], v1, s[4:7], s44 offen offset:2048 sc1
  s_waitcnt vmcnt(9) lgkmcnt(2)
  v_mfma_f32_32x32x16_bf16 v[16:31], v[208:211], a[36:39], v[16:31]
  ds_read_b128 v[224:227], v134 offset:12288
  v_mfma_f32_32x32x16_bf16 v[32:47], v[212:215], a[36:39], v[32:47]
  ds_read_b128 v[228:231], v135 offset:12288
  buffer_load_dwordx4 a[76:79], v1, s[4:7], s44 offen offset:3072 sc1
  s_waitcnt vmcnt(9) lgkmcnt(2)
  v_mfma_f32_32x32x16_bf16 v[16:31], v[216:219], a[40:43], v[16:31]
  ds_read_b128 v[208:211], v134 offset:16384
  v_mfma_f32_32x32x16_bf16 v[32:47], v[220:223], a[40:43], v[32:47]
  ds_read_b128 v[212:215], v135 offset:16384
  s_add_u32 s44, s44, 4096
  buffer_load_dwordx4 a[80:83], v1, s[4:7], s44 offen offset:0 sc1
  s_waitcnt vmcnt(9) lgkmcnt(2)
  v_mfma_f32_32x32x16_bf16 v[16:31], v[224:227], a[44:47], v[16:31]
  ds_read_b128 v[216:219], v134 offset:20480
  v_mfma_f32_32x32x16_bf16 v[32:47], v[228:231], a[44:47], v[32:47]
  ds_read_b128 v[220:223], v135 offset:20480
  buffer_load_dwordx4 a[84:87], v1, s[4:7], s44 offen offset:1024 sc1
  s_waitcnt vmcnt(9) lgkmcnt(2)
  v_mfma_f32_32x32x16_bf16 v[16:31], v[208:211], a[48:51], v[16:31]
  ds_read_b128 v[224:227], v134 offset:24576
  v_mfma_f32_32x32x16_bf16 v[32:47], v[212:215], a[48:51], v[32:47]
  ds_read_b128 v[228:231], v135 offset:24576
  buffer_load_dwordx4 a[88:91], v1, s[4:7], s44 offen offset:2048 sc1
  s_waitcnt vmcnt(9) lgkmcnt(2)
  v_mfma_f32_32x32x16_bf16 v[16:31], v[216:219], a[52:55], v[16:31]
  ds_read_b128 v[208:211], v134 offset:28672
  v_mfma_f32_32x32x16_bf16 v[32:47], v[220:223], a[52:55], v[32:47]
  ds_read_b128 v[212:215], v135 offset:28672
  buffer_load_dwordx4 a[92:95], v1, s[4:7], s44 offen offset:3072 sc1
  s_barrier
  s_waitcnt vmcnt(9) lgkmcnt(2)
  v_mfma_f32_32x32x16_bf16 v[16:31], v[224:227], a[56:59], v[16:31]
  ds_read_b128 v[216:219], v132 offset:0
  v_add_u32 v136, s24, v2
  ds_write_b128 v136, a[160:163] offset:0
  v_mfma_f32_32x32x16_bf16 v[32:47], v[228:231], a[56:59], v[32:47]
  ds_read_b128 v[220:223], v133 offset:0
  s_add_u32 s44, s44, 4096
  buffer_load_dwordx4 a[96:99], v1, s[4:7], s44 offen offset:0 sc1
  s_waitcnt vmcnt(9) lgkmcnt(3)
  v_mfma_f32_32x32x16_bf16 v[16:31], v[208:211], a[60:63], v[16:31]
  ds_read_b128 v[224:227], v132 offset:4096
  ds_write_b128 v136, a[164:167] offset:1024
  ds_write_b128 v136, a[168:171] offset:2048
  v_mfma_f32_32x32x16_bf16 v[32:47], v[212:215], a[60:63], v[32:47]
  ds_read_b128 v[228:231], v133 offset:4096
  buffer_load_dwordx4 a[100:103], v1, s[4:7], s44 offen offset:1024 sc1
  v_add_u32 v134, s53, v5
  v_add_u32 v135, s54, v5
  s_waitcnt vmcnt(9) lgkmcnt(4)
  v_mfma_f32_32x32x16_bf16 v[16:31], v[216:219], a[64:67], v[16:31]
  ds_read_b128 v[208:211], v132 offset:8192
  ds_write_b128 v136, a[172:175] offset:3072
  v_mfma_f32_32x32x16_bf16 v[32:47], v[220:223], a[64:67], v[32:47]
  ds_read_b128 v[212:215], v133 offset:8192
  buffer_load_dwordx4 a[104:107], v1, s[4:7], s44 offen offset:2048 sc1
  s_waitcnt vmcnt(9) lgkmcnt(3)
  v_mfma_f32_32x32x16_bf16 v[16:31], v[224:227], a[68:71], v[16:31]
  ds_read_b128 v[216:219], v132 offset:12288
  ds_write_b128 v136, a[176:179] offset:4096
  v_mfma_f32_32x32x16_bf16 v[32:47], v[228:231], a[68:71], v[32:47]
  ds_read_b128 v[220:223], v133 offset:12288
  buffer_load_dwordx4 a[108:111], v1, s[4:7], s44 offen offset:3072 sc1
  s_waitcnt vmcnt(9) lgkmcnt(3)
  v_mfma_f32_32x32x16_bf16 v[16:31], v[208:211], a[72:75], v[16:31]
  ds_read_b128 v[224:227], v132 offset:16384
  ds_write_b128 v136, a[180:183] offset:5120
  v_mfma_f32_32x32x16_bf16 v[32:47], v[212:215], a[72:75], v[32:47]
  ds_read_b128 v[228:231], v133 offset:16384
  s_add_u32 s44, s44, 4096
  buffer_load_dwordx4 a[112:115], v1, s[4:7], s44 offen offset:0 sc1
  s_waitcnt vmcnt(9) lgkmcnt(3)
  v_mfma_f32_32x32x16_bf16 v[16:31], v[216:219], a[76:79], v[16:31]
  ds_read_b128 v[208:211], v132 offset:20480
  ds_write_b128 v136, a[184:187] offset:6144
  v_mfma_f32_32x32x16_bf16 v[32:47], v[220:223], a[76:79], v[32:47]
  ds_read_b128 v[212:215], v133 offset:20480
  buffer_load_dwordx4 a[116:119], v1, s[4:7], s44 offen offset:1024 sc1
  s_waitcnt vmcnt(9) lgkmcnt(3)
  v_mfma_f32_32x32x16_bf16 v[16:31], v[224:227], a[80:83], v[16:31]
  ds_read_b128 v[216:219], v132 offset:24576
  ds_write_b128 v136, a[188:191] offset:7168
  v_mfma_f32_32x32x16_bf16 v[32:47], v[228:231], a[80:83], v[32:47]
  ds_read_b128 v[220:223], v133 offset:24576
  buffer_load_dwordx4 a[120:123], v1, s[4:7], s44 offen offset:2048 sc1
  s_waitcnt vmcnt(9) lgkmcnt(3)
  v_mfma_f32_32x32x16_bf16 v[16:31], v[208:211], a[84:87], v[16:31]
  ds_read_b128 v[224:227], v132 offset:28672
  v_mfma_f32_32x32x16_bf16 v[32:47], v[212:215], a[84:87], v[32:47]
  ds_read_b128 v[228:231], v133 offset:28672
  buffer_load_dwordx4 a[124:127], v1, s[4:7], s44 offen offset:3072 sc1
  s_barrier
  s_waitcnt vmcnt(9) lgkmcnt(2)
  v_mfma_f32_32x32x16_bf16 v[16:31], v[216:219], a[88:91], v[16:31]
  ds_read_b128 v[208:211], v134 offset:0
  v_add_u32 v136, s24, v3
  ds_write_b128 v136, a[192:195] offset:0
  v_mfma_f32_32x32x16_bf16 v[32:47], v[220:223], a[88:91], v[32:47]
  ds_read_b128 v[212:215], v135 offset:0
  s_add_u32 s44, s44, 4096
  buffer_load_dwordx4 a[0:3], v1, s[4:7], s44 offen offset:0 sc1
  s_waitcnt vmcnt(9) lgkmcnt(3)
  v_mfma_f32_32x32x16_bf16 v[16:31], v[224:227], a[92:95], v[16:31]
  ds_read_b128 v[216:219], v134 offset:4096
  ds_write_b128 v136, a[196:199] offset:1024
  ds_write_b128 v136, a[200:203] offset:2048
  v_mfma_f32_32x32x16_bf16 v[32:47], v[228:231], a[92:95], v[32:47]
  ds_read_b128 v[220:223], v135 offset:4096
  buffer_load_dwordx4 a[4:7], v1, s[4:7], s44 offen offset:1024 sc1
  v_add_u32 v132, s53, v2
  v_add_u32 v133, s54, v2
  s_waitcnt vmcnt(9) lgkmcnt(4)
  v_mfma_f32_32x32x16_bf16 v[16:31], v[208:211], a[96:99], v[16:31]
  ds_read_b128 v[224:227], v134 offset:8192
  ds_write_b128 v136, a[204:207] offset:3072
  v_mfma_f32_32x32x16_bf16 v[32:47], v[212:215], a[96:99], v[32:47]
  ds_read_b128 v[228:231], v135 offset:8192
  buffer_load_dwordx4 a[8:11], v1, s[4:7], s44 offen offset:2048 sc1
  s_waitcnt vmcnt(9) lgkmcnt(3)
  v_mfma_f32_32x32x16_bf16 v[16:31], v[216:219], a[100:103], v[16:31]
  ds_read_b128 v[208:211], v134 offset:12288
  ds_write_b128 v136, a[208:211] offset:4096
  v_mfma_f32_32x32x16_bf16 v[32:47], v[220:223], a[100:103], v[32:47]
  ds_read_b128 v[212:215], v135 offset:12288
  buffer_load_dwordx4 a[12:15], v1, s[4:7], s44 offen offset:3072 sc1
  s_waitcnt vmcnt(9) lgkmcnt(3)
  v_mfma_f32_32x32x16_bf16 v[16:31], v[224:227], a[104:107], v[16:31]
  ds_read_b128 v[216:219], v134 offset:16384
  ds_write_b128 v136, a[212:215] offset:5120
  v_mfma_f32_32x32x16_bf16 v[32:47], v[228:231], a[104:107], v[32:47]
  ds_read_b128 v[220:223], v135 offset:16384
  s_add_u32 s44, s44, 4096
  buffer_load_dwordx4 a[16:19], v1, s[4:7], s44 offen offset:0 sc1
  s_waitcnt vmcnt(9) lgkmcnt(3)
  v_mfma_f32_32x32x16_bf16 v[16:31], v[208:211], a[108:111], v[16:31]
  ds_read_b128 v[224:227], v134 offset:20480
  ds_write_b128 v136, a[216:219] offset:6144
  v_mfma_f32_32x32x16_bf16 v[32:47], v[212:215], a[108:111], v[32:47]
  ds_read_b128 v[228:231], v135 offset:20480
  buffer_load_dwordx4 a[20:23], v1, s[4:7], s44 offen offset:1024 sc1
  s_waitcnt vmcnt(9) lgkmcnt(3)
  v_mfma_f32_32x32x16_bf16 v[16:31], v[216:219], a[112:115], v[16:31]
  ds_read_b128 v[208:211], v134 offset:24576
  ds_write_b128 v136, a[220:223] offset:7168
  v_mfma_f32_32x32x16_bf16 v[32:47], v[220:223], a[112:115], v[32:47]
  ds_read_b128 v[212:215], v135 offset:24576
  buffer_load_dwordx4 a[24:27], v1, s[4:7], s44 offen offset:2048 sc1
  s_waitcnt vmcnt(9) lgkmcnt(3)
  v_mfma_f32_32x32x16_bf16 v[16:31], v[224:227], a[116:119], v[16:31]
  ds_read_b128 v[216:219], v134 offset:28672
  v_mfma_f32_32x32x16_bf16 v[32:47], v[228:231], a[116:119], v[32:47]
  ds_read_b128 v[220:223], v135 offset:28672
  buffer_load_dwordx4 a[28:31], v1, s[4:7], s44 offen offset:3072 sc1
  s_barrier
  s_waitcnt vmcnt(9) lgkmcnt(2)
  v_mfma_f32_32x32x16_bf16 v[16:31], v[208:211], a[120:123], v[16:31]
  ds_read_b128 v[224:227], v132 offset:0
  v_add_u32 v136, s24, v4
  ds_write_b128 v136, a[224:227] offset:0
  v_mfma_f32_32x32x16_bf16 v[32:47], v[212:215], a[120:123], v[32:47]
  ds_read_b128 v[228:231], v133 offset:0
  s_add_u32 s44, s44, 4096
  buffer_load_dwordx4 a[32:35], v1, s[4:7], s44 offen offset:0 sc1
  s_waitcnt vmcnt(9) lgkmcnt(3)
  v_mfma_f32_32x32x16_bf16 v[16:31], v[216:219], a[124:127], v[16:31]
  ds_read_b128 v[208:211], v132 offset:4096
  ds_write_b128 v136, a[228:231] offset:1024
  ds_write_b128 v136, a[232:235] offset:2048
  v_mfma_f32_32x32x16_bf16 v[32:47], v[220:223], a[124:127], v[32:47]
  ds_read_b128 v[212:215], v133 offset:4096
  buffer_load_dwordx4 a[36:39], v1, s[4:7], s44 offen offset:1024 sc1
  v_add_u32 v134, s53, v3
  v_add_u32 v135, s54, v3
  s_waitcnt vmcnt(9) lgkmcnt(4)
  v_mfma_f32_32x32x16_bf16 v[16:31], v[224:227], a[0:3], v[16:31]
  ds_read_b128 v[216:219], v132 offset:8192
  ds_write_b128 v136, a[236:239] offset:3072
  v_mfma_f32_32x32x16_bf16 v[32:47], v[228:231], a[0:3], v[32:47]
  ds_read_b128 v[220:223], v133 offset:8192
  buffer_load_dwordx4 a[40:43], v1, s[4:7], s44 offen offset:2048 sc1
  s_waitcnt vmcnt(9) lgkmcnt(3)
  v_mfma_f32_32x32x16_bf16 v[16:31], v[208:211], a[4:7], v[16:31]
  ds_read_b128 v[224:227], v132 offset:12288
  ds_write_b128 v136, a[240:243] offset:4096
  v_mfma_f32_32x32x16_bf16 v[32:47], v[212:215], a[4:7], v[32:47]
  ds_read_b128 v[228:231], v133 offset:12288
  buffer_load_dwordx4 a[44:47], v1, s[4:7], s44 offen offset:3072 sc1
  s_waitcnt vmcnt(9) lgkmcnt(3)
  v_mfma_f32_32x32x16_bf16 v[16:31], v[216:219], a[8:11], v[16:31]
  ds_read_b128 v[208:211], v132 offset:16384
  ds_write_b128 v136, a[244:247] offset:5120
  v_mfma_f32_32x32x16_bf16 v[32:47], v[220:223], a[8:11], v[32:47]
  ds_read_b128 v[212:215], v133 offset:16384
  s_add_u32 s44, s44, 4096
  buffer_load_dwordx4 a[48:51], v1, s[4:7], s44 offen offset:0 sc1
  s_waitcnt vmcnt(9) lgkmcnt(3)
  v_mfma_f32_32x32x16_bf16 v[16:31], v[224:227], a[12:15], v[16:31]
  ds_read_b128 v[216:219], v132 offset:20480
  ds_write_b128 v136, a[248:251] offset:6144
  v_mfma_f32_32x32x16_bf16 v[32:47], v[228:231], a[12:15], v[32:47]
  ds_read_b128 v[220:223], v133 offset:20480
  buffer_load_dwordx4 a[52:55], v1, s[4:7], s44 offen offset:1024 sc1
  s_waitcnt vmcnt(9) lgkmcnt(3)
  v_mfma_f32_32x32x16_bf16 v[16:31], v[208:211], a[16:19], v[16:31]
  ds_read_b128 v[224:227], v132 offset:24576
  ds_write_b128 v136, a[252:255] offset:7168
  v_mfma_f32_32x32x16_bf16 v[32:47], v[212:215], a[16:19], v[32:47]
  ds_read_b128 v[228:231], v133 offset:24576
  buffer_load_dwordx4 a[56:59], v1, s[4:7], s44 offen offset:2048 sc1
  s_waitcnt vmcnt(9) lgkmcnt(3)
  v_mfma_f32_32x32x16_bf16 v[16:31], v[216:219], a[20:23], v[16:31]
  ds_read_b128 v[208:211], v132 offset:28672
  v_mfma_f32_32x32x16_bf16 v[32:47], v[220:223], a[20:23], v[32:47]
  ds_read_b128 v[212:215], v133 offset:28672
  buffer_load_dwordx4 a[60:63], v1, s[4:7], s44 offen offset:3072 sc1
  s_barrier
  s_waitcnt vmcnt(9) lgkmcnt(2)
  v_mfma_f32_32x32x16_bf16 v[16:31], v[224:227], a[24:27], v[16:31]
  ds_read_b128 v[216:219], v134 offset:0
  v_mfma_f32_32x32x16_bf16 v[32:47], v[228:231], a[24:27], v[32:47]
  ds_read_b128 v[220:223], v135 offset:0
  s_add_u32 s44, s44, 4096
  buffer_load_dwordx4 a[64:67], v1, s[4:7], s44 offen offset:0 sc1
  s_waitcnt vmcnt(9) lgkmcnt(2)
  v_mfma_f32_32x32x16_bf16 v[16:31], v[208:211], a[28:31], v[16:31]
  ds_read_b128 v[224:227], v134 offset:4096
  v_mfma_f32_32x32x16_bf16 v[32:47], v[212:215], a[28:31], v[32:47]
  ds_read_b128 v[228:231], v135 offset:4096
  buffer_load_dwordx4 a[68:71], v1, s[4:7], s44 offen offset:1024 sc1
  v_add_u32 v132, s53, v4
  v_add_u32 v133, s54, v4
  s_waitcnt vmcnt(9) lgkmcnt(2)
  v_mfma_f32_32x32x16_bf16 v[16:31], v[216:219], a[32:35], v[16:31]
  ds_read_b128 v[208:211], v134 offset:8192
  v_mfma_f32_32x32x16_bf16 v[32:47], v[220:223], a[32:35], v[32:47]
  ds_read_b128 v[212:215], v135 offset:8192
  buffer_load_dwordx4 a[72:75], v1, s[4:7], s44 offen offset:2048 sc1
  s_waitcnt vmcnt(9) lgkmcnt(2)
  v_mfma_f32_32x32x16_bf16 v[16:31], v[224:227], a[36:39], v[16:31]
  ds_read_b128 v[216:219], v134 offset:12288
  v_mfma_f32_32x32x16_bf16 v[32:47], v[228:231], a[36:39], v[32:47]
  ds_read_b128 v[220:223], v135 offset:12288
  buffer_load_dwordx4 a[76:79], v1, s[4:7], s44 offen offset:3072 sc1
  s_waitcnt vmcnt(9) lgkmcnt(2)
  v_mfma_f32_32x32x16_bf16 v[16:31], v[208:211], a[40:43], v[16:31]
  ds_read_b128 v[224:227], v134 offset:16384
  v_mfma_f32_32x32x16_bf16 v[32:47], v[212:215], a[40:43], v[32:47]
  ds_read_b128 v[228:231], v135 offset:16384
  s_add_u32 s44, s44, 4096
  buffer_load_dwordx4 a[80:83], v1, s[4:7], s44 offen offset:0 sc1
  s_waitcnt vmcnt(9) lgkmcnt(2)
  v_mfma_f32_32x32x16_bf16 v[16:31], v[216:219], a[44:47], v[16:31]
  ds_read_b128 v[208:211], v134 offset:20480
  v_mfma_f32_32x32x16_bf16 v[32:47], v[220:223], a[44:47], v[32:47]
  ds_read_b128 v[212:215], v135 offset:20480
  buffer_load_dwordx4 a[84:87], v1, s[4:7], s44 offen offset:1024 sc1
  s_waitcnt vmcnt(9) lgkmcnt(2)
  v_mfma_f32_32x32x16_bf16 v[16:31], v[224:227], a[48:51], v[16:31]
  ds_read_b128 v[216:219], v134 offset:24576
  v_mfma_f32_32x32x16_bf16 v[32:47], v[228:231], a[48:51], v[32:47]
  ds_read_b128 v[220:223], v135 offset:24576
  buffer_load_dwordx4 a[88:91], v1, s[4:7], s44 offen offset:2048 sc1
  s_waitcnt vmcnt(9) lgkmcnt(2)
  v_mfma_f32_32x32x16_bf16 v[16:31], v[208:211], a[52:55], v[16:31]
  ds_read_b128 v[224:227], v134 offset:28672
  v_mfma_f32_32x32x16_bf16 v[32:47], v[212:215], a[52:55], v[32:47]
  ds_read_b128 v[228:231], v135 offset:28672
  buffer_load_dwordx4 a[92:95], v1, s[4:7], s44 offen offset:3072 sc1
  s_barrier
  s_waitcnt vmcnt(9) lgkmcnt(2)
  v_mfma_f32_32x32x16_bf16 v[16:31], v[216:219], a[56:59], v[16:31]
  ds_read_b128 v[208:211], v132 offset:0
  v_mfma_f32_32x32x16_bf16 v[32:47], v[220:223], a[56:59], v[32:47]
  ds_read_b128 v[212:215], v133 offset:0
  s_waitcnt vmcnt(8) lgkmcnt(2)
  v_mfma_f32_32x32x16_bf16 v[16:31], v[224:227], a[60:63], v[16:31]
  ds_read_b128 v[216:219], v132 offset:4096
  v_mfma_f32_32x32x16_bf16 v[32:47], v[228:231], a[60:63], v[32:47]
  ds_read_b128 v[220:223], v133 offset:4096
  s_waitcnt vmcnt(7) lgkmcnt(2)
  v_mfma_f32_32x32x16_bf16 v[16:31], v[208:211], a[64:67], v[16:31]
  ds_read_b128 v[224:227], v132 offset:8192
  v_mfma_f32_32x32x16_bf16 v[32:47], v[212:215], a[64:67], v[32:47]
  ds_read_b128 v[228:231], v133 offset:8192
  s_waitcnt vmcnt(6) lgkmcnt(2)
  v_mfma_f32_32x32x16_bf16 v[16:31], v[216:219], a[68:71], v[16:31]
  ds_read_b128 v[208:211], v132 offset:12288
  v_mfma_f32_32x32x16_bf16 v[32:47], v[220:223], a[68:71], v[32:47]
  ds_read_b128 v[212:215], v133 offset:12288
  s_waitcnt vmcnt(5) lgkmcnt(2)
  v_mfma_f32_32x32x16_bf16 v[16:31], v[224:227], a[72:75], v[16:31]
  ds_read_b128 v[216:219], v132 offset:16384
  v_mfma_f32_32x32x16_bf16 v[32:47], v[228:231], a[72:75], v[32:47]
  ds_read_b128 v[220:223], v133 offset:16384
  s_waitcnt vmcnt(4) lgkmcnt(2)
  v_mfma_f32_32x32x16_bf16 v[16:31], v[208:211], a[76:79], v[16:31]
  ds_read_b128 v[224:227], v132 offset:20480
  v_mfma_f32_32x32x16_bf16 v[32:47], v[212:215], a[76:79], v[32:47]
  ds_read_b128 v[228:231], v133 offset:20480
  s_waitcnt vmcnt(3) lgkmcnt(2)
  v_mfma_f32_32x32x16_bf16 v[16:31], v[216:219], a[80:83], v[16:31]
  ds_read_b128 v[208:211], v132 offset:24576
  v_mfma_f32_32x32x16_bf16 v[32:47], v[220:223], a[80:83], v[32:47]
  ds_read_b128 v[212:215], v133 offset:24576
  s_waitcnt vmcnt(2) lgkmcnt(2)
  v_mfma_f32_32x32x16_bf16 v[16:31], v[224:227], a[84:87], v[16:31]
  ds_read_b128 v[216:219], v132 offset:28672
  v_mfma_f32_32x32x16_bf16 v[32:47], v[228:231], a[84:87], v[32:47]
  ds_read_b128 v[220:223], v133 offset:28672
  s_waitcnt vmcnt(1) lgkmcnt(2)
  v_mfma_f32_32x32x16_bf16 v[16:31], v[208:211], a[88:91], v[16:31]
  v_mfma_f32_32x32x16_bf16 v[32:47], v[212:215], a[88:91], v[32:47]
  s_waitcnt vmcnt(0) lgkmcnt(0)
  v_mfma_f32_32x32x16_bf16 v[16:31], v[216:219], a[92:95], v[16:31]
  v_mfma_f32_32x32x16_bf16 v[32:47], v[220:223], a[92:95], v[32:47]
  v_lshlrev_b32 v140, 16, v88
  v_and_b32 v141, 0xffff0000, v88
  v_lshlrev_b32 v142, 16, v89
  v_and_b32 v143, 0xffff0000, v89
  v_lshlrev_b32 v144, 16, v90
  v_and_b32 v145, 0xffff0000, v90
  v_lshlrev_b32 v146, 16, v91
  v_and_b32 v147, 0xffff0000, v91
  v_lshlrev_b32 v148, 16, v92
  v_and_b32 v149, 0xffff0000, v92
  v_lshlrev_b32 v150, 16, v93
  v_and_b32 v151, 0xffff0000, v93
  ds_write_b128 v71, v[32:35] offset:0
  ds_write_b128 v71, v[36:39] offset:1024
  ds_write_b128 v71, v[40:43] offset:2048
  ds_write_b128 v71, v[44:47] offset:3072
  v_lshlrev_b32 v152, 16, v94
  v_and_b32 v153, 0xffff0000, v94
  v_lshlrev_b32 v154, 16, v95
  v_and_b32 v155, 0xffff0000, v95
  v_add_f32 v140, v140, v16
  v_add_f32 v141, v141, v17
  v_add_f32 v142, v142, v18
  v_add_f32 v143, v143, v19
  v_add_f32 v144, v144, v20
  v_add_f32 v145, v145, v21
  v_add_f32 v146, v146, v22
  v_add_f32 v147, v147, v23
  v_add_f32 v148, v148, v24
  v_add_f32 v149, v149, v25
  v_add_f32 v150, v150, v26
  v_add_f32 v151, v151, v27
  v_add_f32 v152, v152, v28
  v_add_f32 v153, v153, v29
  v_add_f32 v154, v154, v30
  v_add_f32 v155, v155, v31
  s_waitcnt lgkmcnt(0)
  s_barrier
  ds_read_b128 v[48:51], v72 offset:0
  ds_read_b128 v[52:55], v72 offset:1024
  ds_read_b128 v[56:59], v72 offset:2048
  ds_read_b128 v[60:63], v72 offset:3072
  s_waitcnt lgkmcnt(3)
  v_add_f32 v140, v140, v48
  v_add_f32 v141, v141, v49
  v_add_f32 v142, v142, v50
  v_add_f32 v143, v143, v51
  v_cvt_pk_bf16_f32 v88, v140, v141
  v_cvt_pk_bf16_f32 v89, v142, v143
  s_waitcnt lgkmcnt(2)
  v_add_f32 v144, v144, v52
  v_add_f32 v145, v145, v53
  v_add_f32 v146, v146, v54
  v_add_f32 v147, v147, v55
  v_cvt_pk_bf16_f32 v90, v144, v145
  v_cvt_pk_bf16_f32 v91, v146, v147
  s_waitcnt lgkmcnt(1)
  v_add_f32 v148, v148, v56
  v_add_f32 v149, v149, v57
  v_add_f32 v150, v150, v58
  v_add_f32 v151, v151, v59
  v_cvt_pk_bf16_f32 v92, v148, v149
  v_cvt_pk_bf16_f32 v93, v150, v151
  s_waitcnt lgkmcnt(0)
  v_add_f32 v152, v152, v60
  v_add_f32 v153, v153, v61
  v_add_f32 v154, v154, v62
  v_add_f32 v155, v155, v63
  v_cvt_pk_bf16_f32 v94, v152, v153
  v_cvt_pk_bf16_f32 v95, v154, v155
  s_cmp_eq_u32 s15, 1
  s_cbranch_scc1 fin___prompt_44
  s_cmp_lg_u32 s16, 0
  s_cbranch_scc1 st___prompt_46
  buffer_store_dwordx4 v[88:91], v1, s[4:7], s82 offen
  buffer_store_dwordx4 v[92:95], v1, s[4:7], s82 offen offset:1024
  s_branch sd___prompt_47
st___prompt_46:
  buffer_store_dwordx4 v[88:91], v1, s[4:7], s82 offen sc1
  buffer_store_dwordx4 v[92:95], v1, s[4:7], s82 offen offset:1024 sc1
sd___prompt_47:
  v_add_f32 v138, v140, v144
  v_add_f32 v134, v141, v145
  v_add_f32 v135, v142, v146
  v_add_f32 v136, v143, v147
  v_add_f32 v138, v138, v148
  v_add_f32 v134, v134, v149
  v_add_f32 v135, v135, v150
  v_add_f32 v136, v136, v151
  v_add_f32 v138, v138, v152
  v_add_f32 v134, v134, v153
  v_add_f32 v135, v135, v154
  v_add_f32 v136, v136, v155
  v_add_f32 v138, v138, v134
  v_add_f32 v135, v135, v136
  s_nop 0
  v_add_f32 v138, v138, v135
  s_nop 0
  v_mov_b32 v134, v138
  s_nop 1
  v_permlane32_swap_b32 v138, v134
  s_nop 0
  v_add_f32 v138, v138, v134
  s_nop 0
  v_mul_f32 v137, 0xbd000000, v138
  s_nop 0
  v_add_f32 v140, v140, v137
  v_add_f32 v141, v141, v137
  v_add_f32 v142, v142, v137
  v_add_f32 v143, v143, v137
  v_add_f32 v144, v144, v137
  v_add_f32 v145, v145, v137
  v_add_f32 v146, v146, v137
  v_add_f32 v147, v147, v137
  v_add_f32 v148, v148, v137
  v_add_f32 v149, v149, v137
  v_add_f32 v150, v150, v137
  v_add_f32 v151, v151, v137
  v_add_f32 v152, v152, v137
  v_add_f32 v153, v153, v137
  v_add_f32 v154, v154, v137
  v_add_f32 v155, v155, v137
  v_mul_f32 v139, v140, v140
  v_mul_f32 v134, v141, v141
  v_mul_f32 v135, v142, v142
  v_mul_f32 v136, v143, v143
  v_fmac_f32 v139, v144, v144
  v_fmac_f32 v134, v145, v145
  v_fmac_f32 v135, v146, v146
  v_fmac_f32 v136, v147, v147
  v_fmac_f32 v139, v148, v148
  v_fmac_f32 v134, v149, v149
  v_fmac_f32 v135, v150, v150
  v_fmac_f32 v136, v151, v151
  v_fmac_f32 v139, v152, v152
  v_fmac_f32 v134, v153, v153
  v_fmac_f32 v135, v154, v154
  v_fmac_f32 v136, v155, v155
  v_add_f32 v139, v139, v134
  v_add_f32 v135, v135, v136
  s_nop 0
  v_add_f32 v139, v139, v135
  s_nop 0
  v_mov_b32 v134, v139
  s_nop 1
  v_permlane32_swap_b32 v139, v134
  s_nop 0
  v_add_f32 v139, v139, v134
  s_cmp_lg_u32 s16, 0
  s_cbranch_scc1 st___prompt_48
  buffer_store_dwordx2 v[138:139], v7, s[4:7], s83 offen
  s_branch sd___prompt_49
st___prompt_48:
  buffer_store_dwordx2 v[138:139], v7, s[4:7], s83 offen sc1
sd___prompt_49:
  v_add_u32 v248, s24, v2
  ds_write_b128 v248, v[172:175] offset:0
  ds_write_b128 v248, v[176:179] offset:1024
  ds_write_b128 v248, v[180:183] offset:2048
  ds_write_b128 v248, v[184:187] offset:3072
  ds_write_b128 v248, v[188:191] offset:4096
  ds_write_b128 v248, v[192:195] offset:5120
  ds_write_b128 v248, v[196:199] offset:6144
  ds_write_b128 v248, v[200:203] offset:7168
  s_add_u32 s40, s23, s24
  s_add_u32 s41, s25, s24
  s_mov_b32 m0, s40
  s_nop 0
  buffer_load_dwordx4 v1, s[4:7], s41 offen offset:0 lds
  buffer_load_dwordx4 v1, s[4:7], s41 offen offset:1024 lds
  buffer_load_dwordx4 v1, s[4:7], s41 offen offset:2048 lds
  buffer_load_dwordx4 v1, s[4:7], s41 offen offset:3072 lds
  s_add_u32 m0, s40, 4096
  s_add_u32 s41, s41, 4096
  buffer_load_dwordx4 v1, s[4:7], s41 offen offset:0 lds
  buffer_load_dwordx4 v1, s[4:7], s41 offen offset:1024 lds
  buffer_load_dwordx4 v1, s[4:7], s41 offen offset:2048 lds
  buffer_load_dwordx4 v1, s[4:7], s41 offen offset:3072 lds
  s_branch pdone___prompt_45
fin___prompt_44:
  v_permlane32_swap_b32 v88, v90
  v_permlane32_swap_b32 v89, v91
  v_permlane32_swap_b32 v92, v94
  v_permlane32_swap_b32 v93, v95
  s_mov_b32 s44, s90
  v_and_b32 v132, 31, v0
  v_lshlrev_b32 v132, 10, v132
  v_lshrrev_b32 v133, 5, v0
  v_lshlrev_b32 v133, 4, v133
  v_add_u32 v132, v132, v133
  buffer_store_dwordx4 v[88:91], v132, s[8:11], s44 offen
  buffer_store_dwordx4 v[92:95], v132, s[8:11], s44 offen offset:32
  s_cmp_lg_u32 s2, 0
  s_cbranch_scc1 ep___prompt_50
  s_cmp_lg_u32 s12, 0
  s_cbranch_scc1 ep___prompt_50
  v_mov_b32 v9, s39
  v_mov_b32 v10, 28672
  s_mov_b64 exec, 1
  buffer_store_dword v9, v10, s[4:7], 0 offen sc1
  s_mov_b64 exec, -1
ep___prompt_50:
  s_branch L_k1_end
pdone___prompt_45:
  s_waitcnt vmcnt(8) lgkmcnt(0)
  s_barrier
  s_add_u32 s17, s17, 1
  s_cmp_lg_u32 s12, 0
  s_cbranch_scc1 hop___prompt_51
  s_lshl_b32 s45, s14, 2
  s_add_u32 s45, s45, s37
  v_mov_b32 v10, s17
  v_mov_b32 v11, 0
  s_mov_b64 exec, 1
  s_cmp_lg_u32 s16, 0
  s_cbranch_scc1 fs___prompt_52
  buffer_store_dword v10, v11, s[4:7], s45 offen
  s_branch fd___prompt_53
fs___prompt_52:
  buffer_store_dword v10, v11, s[4:7], s45 offen sc1
fd___prompt_53:
  s_mov_b64 exec, -1
  s_mov_b32 s46, 0
poll___prompt_54:
  s_add_u32 s46, s46, 1
  s_cmp_gt_u32 s46, 4194304
  s_cbranch_scc1 pollt___prompt_56
  buffer_load_dword v9, v8, s[4:7], s37 offen sc1
  s_waitcnt vmcnt(0)
  v_subrev_u32 v10, s17, v9
  v_cmp_le_u32 vcc, 8, v10
  s_cbranch_vccz pollx___prompt_55
  s_branch poll___prompt_54
pollt___prompt_56:
  s_mov_b32 s18, 1
pollx___prompt_55:
hop___prompt_51:
  s_barrier
  s_add_u32 s87, s87, 16777216
  s_add_u32 s86, s86, 16777216
  s_add_u32 s89, s89, 4096
  s_add_u32 s88, s88, 4096
  s_add_u32 s15, s15, 1
  s_mov_b32 s94, 0
  s_mov_b32 s95, 0
  s_mov_b32 s40, s23
  s_mov_b32 s23, s22
  s_mov_b32 s22, s21
  s_mov_b32 s21, s20
  s_mov_b32 s20, s40
  v_add_u32 v2, s20, v1
  v_add_u32 v3, s21, v1
  v_add_u32 v4, s22, v1
  v_add_u32 v5, s23, v1
  s_branch L_k1_layer
L_k1_end:
L_k1_last:
  s_endpgm
.section .rodata,"a"
.p2align 6
.amdhsa_kernel interleave_layers__linear_attn_block__glu_gated_swiglu__prompt_kernel
  .amdhsa_next_free_vgpr 512
  .amdhsa_next_free_sgpr 100
  .amdhsa_accum_offset 256
  .amdhsa_group_segment_fixed_size 0
  .amdhsa_kernarg_size 80
  .amdhsa_user_sgpr_count 2
  .amdhsa_user_sgpr_kernarg_segment_ptr 1
  .amdhsa_system_sgpr_workgroup_id_x 1
  .amdhsa_float_denorm_mode_32 3
.end_amdhsa_kernel
```
